```python
import torch

def _softmax(x, axis=-1):
    return torch.softmax(x, dim=axis)

def _gelu(x):
    return torch.nn.functional.gelu(x, approximate='tanh')

def _silu(x):
    return torch.nn.functional.silu(x)

def _sigmoid(x):
    return torch.sigmoid(x)

def _layernorm(x, axis=-1, eps=1e-05):
    m = x.mean(dim=axis, keepdim=True)
    v = x.var(dim=axis, keepdim=True, unbiased=False)
    return (x - m) / torch.sqrt(v + eps)

def _scatter_add(tgt, idx, src, axis=0):
    return tgt.clone().index_add_(axis, idx, src)

def _segment_sum(src, seg, n):
    out = torch.zeros((n,) + src.shape[1:], dtype=src.dtype)
    return out.index_add_(0, seg, src)

def _pad(x, pw):
    flat = tuple((v for pair in reversed(pw) for v in pair))
    return torch.nn.functional.pad(x, flat)
kernel_name = 'adaLN_cond__ssm_conv_s4__glu_gated_glu__prompt'

def setup_inputs():

    _w = lambda a: (lambda t: t.to(torch.bfloat16) if t.is_floating_point() else t)(torch.as_tensor(a))

    def _A_setup():
        B, L, D, N = (1, 2048, 448, 256)
        A_re = -(lambda _x: torch.exp(torch.as_tensor(_x)))((lambda *s: torch.randn(*s, dtype=torch.bfloat16) * 3.2)(D, N))
        A_im = torch.pi * (lambda *s: torch.randn(*s, dtype=torch.bfloat16) * 0.2)(D, N)
        B_re = (lambda *s: torch.randn(*s, dtype=torch.bfloat16) * 0.2)(D, N)
        B_im = (lambda *s: torch.randn(*s, dtype=torch.bfloat16) * 0.2)(D, N)
        C_re = (lambda *s: torch.randn(*s, dtype=torch.bfloat16) * 0.2)(D, N)
        C_im = (lambda *s: torch.randn(*s, dtype=torch.bfloat16) * 0.2)(D, N)
        log_dt = (lambda *s: torch.randn(*s, dtype=torch.bfloat16) * 0.2)(D) * 0.5 - 4.0
        Dskip = (lambda *s: torch.randn(*s, dtype=torch.bfloat16) * 0.2)(D)
        return {'u': _w((lambda *s: torch.randn(*s, dtype=torch.bfloat16) * 0.05)(B, L, D)), 'A_re': _w(A_re), 'A_im': _w(A_im), 'B_re': _w(B_re), 'B_im': _w(B_im), 'C_re': _w(C_re), 'C_im': _w(C_im), 'log_dt': _w(log_dt), 'Dskip': _w(Dskip)}
    _A_in = _A_setup()

    def _B_setup():
        B, S, D, F = (1, 2048, 448, 1792)
        return {'x': _w((lambda *s: torch.randn(*s, dtype=torch.bfloat16) * 0.05)(B, S, D)), 'w_gate': _w((lambda *s: torch.randn(*s, dtype=torch.bfloat16) * 0.4)(D, F)), 'w_up': _w((lambda *s: torch.randn(*s, dtype=torch.bfloat16) * 0.2)(D, F)), 'w_down': _w((lambda *s: torch.randn(*s, dtype=torch.bfloat16) * 0.2)(F, D))}
    _B_in = _B_setup()
    return {'A_u': _A_in['u'], 'A_A_re': _A_in['A_re'], 'A_A_im': _A_in['A_im'], 'A_B_re': _A_in['B_re'], 'A_B_im': _A_in['B_im'], 'A_C_re': _A_in['C_re'], 'A_C_im': _A_in['C_im'], 'A_log_dt': _A_in['log_dt'], 'A_Dskip': _A_in['Dskip'], 'B_x': _B_in['x'], 'B_w_gate': _B_in['w_gate'], 'B_w_up': _B_in['w_up'], 'B_w_down': _B_in['w_down'], 'c': _w((lambda *s: torch.randn(*s, dtype=torch.bfloat16) * 0.4)(1, 448) * 8.0), 'w_mod': _w((lambda *s: torch.randn(*s, dtype=torch.bfloat16) * 0.4)(448, 6 * 448) * 448 ** (-0.5) * 8.0)}

def reference(A_u, A_A_re, A_A_im, A_B_re, A_B_im, A_C_re, A_C_im, A_log_dt, A_Dskip, B_x, B_w_gate, B_w_up, B_w_down, c, w_mod):

    def _A_ref(u, A_re, A_im, B_re, B_im, C_re, C_im, log_dt, Dskip):
        Bsz, L, D = u.shape
        dt = torch.exp(log_dt)[:, None]
        A = A_re + 1j * A_im
        Bc = B_re + 1j * B_im
        Cc = C_re + 1j * C_im
        logdA = dt * A
        dB = dt * Bc
        l = (lambda x, dt: x.to(dt))(torch.arange(L), A_re.dtype)
        P = torch.exp(logdA[:, :, None] * l[None, None, :])
        K = torch.einsum('dn,dnl,dn->dl', Cc, P, dB).real
        L2 = 2 * L
        Kp = _pad(K, ((0, 0), (0, L)))
        up = (lambda x, *d: x.permute(*d))(u, 0, 2, 1)
        up = _pad(up, ((0, 0), (0, 0), (0, L)))
        Kf = (lambda x, axes=(-2, -1): torch.fft.rfft2(x.float(), dim=axes))(Kp[:, None, :], axes=(-2, -1))
        Uf = (lambda x, axes=(-2, -1): torch.fft.rfft2(x.float(), dim=axes))(up[:, :, None, :], axes=(-2, -1))
        Yf = Uf * Kf[None, :, :, :]
        y = (lambda x, s, axes=(-2, -1): torch.fft.irfft2(x, s=s, dim=axes).to(torch.bfloat16))(Yf, (1, L2), axes=(-2, -1))[:, :, 0, :L]
        y = (lambda x, *d: x.permute(*d))(y, 0, 2, 1) + u * Dskip[None, None, :]
        return y

    def _B_ref(x, w_gate, w_up, w_down):
        g = torch.einsum('bsd,df->bsf', x, w_gate)
        u = torch.einsum('bsd,df->bsf', x, w_up)
        h = _sigmoid(g) * u
        return torch.einsum('bsf,fd->bsd', h, w_down)
    x = A_u
    mod = (_silu(c) @ w_mod).reshape(c.shape[0], 6, 1, -1)
    sa, ca, ga, sb, cb, gb = (mod[:, 0].clone(), mod[:, 1].clone(), mod[:, 2].clone(), mod[:, 3].clone(), mod[:, 4].clone(), mod[:, 5].clone())
    h = _layernorm(x, axis=-1) * (1 + ca) + sa
    x = x + ga * _A_ref(h, A_A_re, A_A_im, A_B_re, A_B_im, A_C_re, A_C_im, A_log_dt, A_Dskip)
    h = _layernorm(x, axis=-1) * (1 + cb) + sb
    x = x + gb * _B_ref(h, B_w_gate, B_w_up, B_w_down)
    return x
```

```asm
; @launch kernel=kf_kernel grid=(256,1,1) block=(512,1,1) lds=163840
.amdgcn_target "amdgcn-amd-amdhsa--gfx950"
.text
.globl kf_kernel
.p2align 12
.type kf_kernel,@function
kf_kernel:
  s_cmp_ge_u32 s2, 256
  s_cbranch_scc1 K1_EXIT
  s_load_dwordx16 s[8:23], s[0:1], 0
  s_load_dwordx2 s[28:29], s[0:1], 136
  s_bfe_u32 s3, s2, 0x30005
  s_cmp_lg_u32 s3, 1
  s_cbranch_scc1 K1_NCP
  v_cmp_gt_u32 vcc, 64, v0
  s_nop 0
  s_nop 3
  s_cbranch_vccz K1_NCP
  s_getpc_b64 s[40:41]
K1_PC0:
  s_and_b32 s3, s2, 24
  s_lshl_b32 s3, s3, 10
  v_lshl_add_u32 v3, v0, 7, s3
  v_min_u32 v3, K_END-K1_PC0-4, v3
  global_load_dword v149, v3, s[40:41]
K1_NCP:
  s_load_dwordx2 s[56:57], s[0:1], 128
  s_load_dwordx8 s[44:51], s[0:1], 64
  s_load_dwordx2 s[94:95], s[0:1], 96
  s_load_dwordx2 s[96:97], s[0:1], 112
  s_load_dwordx2 s[98:99], s[0:1], 104
  s_mov_b32 s30, 13115392
  s_mov_b32 s31, 0x00020000
  s_movk_i32 s58, 256
  s_mov_b32 s59, 0x00020000
  s_mov_b32 s82, 1605632
  s_mov_b32 s83, 0x00020000
  v_and_b32 v1, 63, v0
  v_lshrrev_b32 v2, 6, v0
  s_nop 0
  v_readfirstlane_b32 s87, v2
  v_mov_b32 v20, 0
  v_mov_b32 v21, 0
  v_mov_b32 v22, 0
  v_mov_b32 v23, 0
  s_mov_b32 s52, -1
  s_mov_b32 s53, 0x00ffffff
  s_cmp_lt_u32 s2, 224
  s_cbranch_scc1 K1_NCL
  s_cmp_lt_u32 s2, 245
  s_cbranch_scc1 K1_SPARE
  v_lshlrev_b32 v6, 4, v0
  s_lshl_b32 s60, s2, 13
  s_lshl_b32 s61, s2, 14
  s_add_u32 s60, s60, 10838016
  s_add_u32 s61, s61, 8921088
  s_add_u32 s62, s61, 8192
  s_waitcnt lgkmcnt(0)
  buffer_store_dwordx4 v[20:23], v6, s[28:31], s60 offen sc1
  buffer_store_dwordx4 v[20:23], v6, s[28:31], s61 offen sc1
  buffer_store_dwordx4 v[20:23], v6, s[28:31], s62 offen sc1
  v_mov_b32 v16, -1
  s_cmp_ge_u32 s2, 252
  s_addc_u32 s61, s2, -245
  s_lshl_b32 s61, s61, 4
  s_cmp_lg_u32 s87, 0
  s_waitcnt vmcnt(0)
  s_barrier
  s_cbranch_scc1 K1_SPARE
  s_mov_b64 exec, 1
  buffer_store_dword v16, off, s[56:59], s61 sc1
  s_mov_b64 exec, -1
  s_branch K1_SPARE
K1_NCL:
  s_lshl_b32 s3, s2, 3
  s_add_u32 s3, s3, s87
  s_mul_i32 s3, s3, 896
  v_lshl_add_u32 v5, v1, 4, s3
  v_mov_b32 v243, v0
  v_and_b32 v0, 255, v0
  s_and_b32 s4, s87, 3
  s_lshr_b32 s36, s87, 2
  s_and_b32 s62, s2, 7
  s_mul_i32 s62, s62, 56
  s_lshr_b32 s5, s2, 3
  s_lshl_b32 s5, s5, 1
  s_add_u32 s62, s62, s5
  s_add_u32 s62, s62, s36
  s_lshl_b32 s3, s62, 9
  v_lshl_add_u32 v3, v0, 1, s3
  s_lshl_b32 s5, s62, 1
  v_mov_b32 v4, s5
  v_mov_b32 v10, 0
  v_mov_b32 v11, 0
  v_mov_b32 v12, 0
  v_mov_b32 v13, 0
  v_mov_b32 v14, 0
  v_mov_b32 v15, 0
  v_mov_b32 v16, 0
  v_mov_b32 v9, 0
  v_lshlrev_b32 v19, 4, v0
  s_getpc_b64 s[40:41]
K1_PC:
  s_add_u32 s40, s40, KTAB-K1_PC
  s_addc_u32 s41, s41, 0
  v_mov_b32 v44, 0
  v_mov_b32 v45, 0
  v_mov_b32 v46, 0
  v_mov_b32 v47, 0
  s_mov_b64 exec, s[52:53]
  s_sub_u32 s63, s2, 96
  s_mov_b32 s101, 1
  s_cmp_lg_u32 s36, 0
  s_waitcnt lgkmcnt(0)
  s_cbranch_scc1 K1_RH
  global_load_dwordx4 v[20:23], v5, s[8:9]
  global_load_dwordx4 v[44:47], v5, s[8:9] offset:3584
  s_branch K1_R1
K1_RH:
  s_mov_b32 s101, 2
  s_cmp_ge_u32 s63, 64
  s_cbranch_scc1 K1_R1
  s_mul_i32 s61, s2, 3584
  s_sub_u32 s61, 1257984, s61
  v_add_u32 v6, s61, v5
  s_mov_b32 s101, 0
  global_load_dwordx4 v[20:23], v6, s[8:9]
K1_R1:
  s_mov_b64 exec, -1
  global_load_short_d16_hi v16, v4, s[22:23]
  global_load_short_d16_hi v10, v3, s[10:11]
  global_load_short_d16_hi v11, v3, s[12:13]
  global_load_short_d16_hi v12, v3, s[14:15]
  global_load_short_d16_hi v13, v3, s[16:17]
  global_load_short_d16_hi v14, v3, s[18:19]
  global_load_short_d16_hi v15, v3, s[20:21]
  global_load_dwordx4 v[100:103], v19, s[40:41] offset:16
  global_load_dwordx2 v[128:129], v19, s[40:41] offset:8
  global_load_short_d16_hi v9, v4, s[44:45]
  s_mul_i32 s42, s4, 960
  s_lshl_b32 s43, s36, 13
  s_add_u32 s42, s42, s43
  s_add_u32 s42, s42, 111936
  v_lshlrev_b32 v139, 4, v1
  v_min_u32 v137, 896, v139
  v_add_u32 v137, s42, v137
  s_lshl4_add_u32 s42, s36, s4
  s_lshl2_add_u32 s42, s42, 119616
  v_mov_b32 v138, s42
  v_bfe_u32 v148, v1, 2, 2
  v_mul_u32_u24 v148, 960, v148
  v_lshrrev_b32 v147, 4, v1
  v_lshl_add_u32 v148, v147, 5, v148
  v_and_b32 v147, 3, v1
  v_lshl_add_u32 v148, v147, 3, v148
  s_lshl_b32 s42, s87, 7
  s_add_u32 s42, s42, 111936
  v_add_u32 v148, s42, v148
  v_and_b32 v147, 80, v139
  v_add_u32 v147, 119616, v147
  s_mov_b32 s54, 0x3f803f80
  s_mov_b32 s55, 0xffff0000
  s_mul_i32 s26, s2, 7168
  s_lshl_b32 s27, s87, 10
  s_add_u32 s26, s26, s27
  s_add_u32 s26, s26, 0
  s_lshl_b32 s27, s4, 8
  s_add_u32 s27, s27, s2
  s_lshl_b32 s27, s27, 5
  s_add_u32 s27, s27, 12845056
  s_bitcmp1_b32 s87, 0
  s_cselect_b32 s80, s50, s48
  s_cselect_b32 s81, s51, s49
  v_min_u32 v165, 11, v1
  v_lshlrev_b32 v165, 4, v165
  v_mov_b32 v248, v139
  v_and_b32 v5, 15, v1
  v_lshrrev_b32 v6, 4, v1
  s_mul_i32 s7, s36, 55968
  s_lshl_b32 s6, s4, 8
  s_add_u32 s6, s6, s7
  s_lshl_b32 s8, s36, 15
  v_bfe_i32 v167, v1, 1, 1
  v_bfi_b32 v167, v167, 0, s8
  v_and_or_b32 v167, v139, 16, v167
  s_cmp_lg_u32 s87, 7
  s_cselect_b32 s10, 0x13, 0
  s_mov_b32 s11, 0
  s_cmp_lt_u32 s63, 64
  s_cselect_b32 s12, 0x5f, 0x0f
  s_and_b32 s10, s10, s12
  s_lshl_b32 s13, s63, 4
  s_lshl_b32 s14, s2, 5
  s_sub_u32 s13, s13, s14
  s_add_u32 s13, s13, 7168
  v_bfe_i32 v17, v1, 2, 1
  v_and_b32 v17, s13, v17
  v_add_u32 v167, v167, v17
  s_mov_b32 m0, s6
  v_mov_b32 v88, 0x3f80
  ds_write_addtid_b32 v88
  s_mul_i32 s40, s36, 4608
  s_add_u32 s40, s40, 114688
  s_lshl_b32 s18, s36, 1
  s_sub_u32 s18, 5, s18
  s_lshl_b32 s42, s4, 6
  v_lshrrev_b32 v151, 1, v1
  v_add_u32 v151, s42, v151
  v_and_b32 v17, 1, v1
  v_mul_u32_u24 v150, 7168, v151
  v_lshl_add_u32 v150, v17, 4, v150
  v_lshlrev_b32 v151, 4, v151
  v_lshl_add_u32 v151, v17, 15, v151
  v_lshlrev_b32 v166, 5, v0
  s_mov_b32 s50, 0
  s_mov_b64 s[46:47], -1
  s_and_b32 s32, s62, -2
  s_lshl_b32 s32, s32, 4
  s_add_u32 s32, s32, 0
  s_lshr_b32 s60, s62, 6
  s_lshl_b32 s60, s60, 13
  s_add_u32 s60, s60, 12845056
  v_min_u32 v18, 47, v1
  v_bfe_u32 v136, v18, 2, 2
  v_mul_u32_u24 v136, 4160, v136
  v_and_b32 v18, 3, v18
  v_lshl_add_u32 v136, v18, 4, v136
  v_add_u32 v136, 4096, v136
  v_add_u32 v17, 16640, v139
  v_cmp_gt_u32 vcc, 32, v1
  s_nop 1
  v_cndmask_b32 v136, v136, v17, vcc
  v_add_u32 v136, s8, v136
  s_lshr_b32 s5, s2, 3
  s_bfe_u32 s7, s2, 0x10002
  s_mul_i32 s9, s5, 37
  s_lshr_b32 s9, s9, 8
  s_sub_u32 s88, s9, 3
  s_min_u32 s89, s9, s88
  s_mul_i32 s88, s89, 229376
  s_lshl_b32 s89, s89, 13
  s_sub_u32 s9, s7, s9
  s_mul_i32 s9, s9, 7
  s_add_u32 s5, s5, s9
  v_lshrrev_b32 v140, 4, v1
  s_and_b32 s85, s87, 1
  s_lshl_b32 s86, s85, 2
  v_or_b32 v240, s86, v140
  v_lshlrev_b32 v240, 5, v240
  v_and_b32 v141, 15, v1
  v_lshlrev_b32 v141, 4, v141
  v_xor_b32 v240, v240, v141
  v_mul_u32_u24 v141, 3584, v140
  v_add_u32 v240, v240, v141
  s_lshl_b32 s86, s85, 13
  s_lshr_b32 s85, s87, 1
  s_mul_i32 s84, s85, 28672
  s_lshl_b32 s85, s85, 11
  s_add_u32 s86, s86, s85
  s_lshl_b32 s85, s5, 8
  s_add_u32 s84, s84, s85
  v_and_b32 v140, 1, v140
  v_bfe_u32 v141, v1, 2, 2
  v_lshrrev_b32 v241, 5, v1
  v_lshl_add_u32 v241, v241, 3, v141
  v_lshlrev_b32 v241, 8, v241
  v_lshl_add_u32 v241, v140, 13, v241
  v_lshl_or_b32 v140, v140, 2, v141
  v_xor_b32 v140, s87, v140
  v_lshl_add_u32 v241, v140, 5, v241
  v_and_b32 v140, 1, v1
  v_lshl_add_u32 v241, v140, 4, v241
  v_and_b32 v140, 2, v1
  v_lshl_add_u32 v241, v140, 2, v241
  v_add_u32 v241, 65536, v241
  v_add_u32 v242, 49152, v241
  s_add_u32 s90, s84, 688128
  v_lshrrev_b32 v250, 3, v0
  v_mul_u32_u24 v250, 57344, v250
  v_and_b32 v141, 7, v0
  v_lshl_add_u32 v250, v141, 4, v250
  s_lshl_b32 s34, s62, 7
  s_add_u32 s35, s34, 3670016
  s_add_u32 s34, s34, 1835008
  v_mov_b32 v244, -1
  v_mov_b32 v245, -1
  v_mov_b32 v246, -1
  v_mov_b32 v247, -1
  v_sub_u32 v140, 3, v5
  v_and_b32 v140, 3, v140
  v_mul_u32_u24 v236, 4158, v140
  v_lshl_add_u32 v236, v6, 4, v236
  v_lshlrev_b32 v140, 1, v5
  v_sub_u32 v236, v236, v140
  s_lshl_b32 s42, s4, 7
  s_sub_u32 s42, s42, s8
  s_sub_u32 s43, 414, s42
  v_add_u32 v236, s43, v236
  v_lshlrev_b32 v237, 5, v5
  v_lshl_add_u32 v237, v6, 4, v237
  s_sub_u32 s43, 17056, s42
  v_add_u32 v237, s43, v237
  v_bfe_u32 v238, v0, 1, 4
  v_and_b32 v140, 1, v0
  v_lshlrev_b32 v141, 3, v140
  v_xor_b32 v238, v238, v141
  v_lshlrev_b32 v238, 4, v238
  v_lshl_add_u32 v238, v140, 9, v238
  v_lshrrev_b32 v140, 5, v0
  v_lshl_add_u32 v238, v140, 10, v238
  v_add_u32 v238, s8, v238
  v_lshlrev_b32 v239, 2, v1
  v_and_b32 v239, 128, v239
  v_xor_b32 v239, v239, v248
  v_lshl_add_u32 v239, v2, 13, v239
  s_lshl_b32 s33, s62, 2
  s_add_u32 s33, s33, 12902400
  v_lshrrev_b32 v251, 1, v1
  v_min_u32 v251, 4, v251
  v_mul_u32_u24 v251, 1792, v251
  s_cmp_gt_u32 s4, 0
  s_cselect_b32 s37, 1.0, 0
  s_cmp_gt_u32 s4, 1
  s_cselect_b32 s38, 1.0, 0
  s_cmp_gt_u32 s4, 2
  s_cselect_b32 s39, 1.0, 0
  s_cmp_ge_u32 s87, 4
  s_cbranch_scc1 K1_HF1
  s_movk_i32 s41, 1056
  s_lshr_b32 s42, s4, 1
  s_mul_i32 s43, s42, 4608
  s_mul_i32 s42, s42, 55968
  v_lshl_add_u32 v106, v6, 4, s42
  v_mad_u32_u24 v105, v5, s41, v106
  v_min_u32 v107, 4, v5
  v_mad_u32_u24 v106, v107, s41, v106
  s_and_b32 s42, s4, 1
  s_lshl_b32 s9, s42, 6
  s_mul_i32 s42, s42, 16896
  v_add_u32 v107, s42, v105
  s_add_u32 s43, s43, s9
  s_add_u32 s43, s43, 114688
  v_mul_u32_u24 v109, 144, v5
  v_lshl_add_u32 v110, v6, 4, s43
  v_add_u32 v109, v109, v110
  s_nop 1
K1_HF1:
  s_mov_b64 exec, 0
  s_branch K1C_H0
K1C_HE:
  s_mov_b64 exec, -1
  s_nop 0
  s_waitcnt vmcnt(10)
  s_cmp_lg_u32 s101, 1
  s_cbranch_scc1 K1_LNC
  v_dot2_f32_bf16 v24, v20, s54, 0
  v_dot2_f32_bf16 v48, v44, s54, 0
  v_dot2_f32_bf16 v26, v20, v20, 0
  v_dot2_f32_bf16 v50, v44, v44, 0
  v_dot2_f32_bf16 v25, v21, s54, 0
  v_dot2_f32_bf16 v49, v45, s54, 0
  v_dot2_f32_bf16 v27, v21, v21, 0
  v_dot2_f32_bf16 v51, v45, v45, 0
  v_dot2_f32_bf16 v24, v22, s54, v24
  v_dot2_f32_bf16 v48, v46, s54, v48
  v_dot2_f32_bf16 v26, v22, v22, v26
  v_dot2_f32_bf16 v50, v46, v46, v50
  v_dot2_f32_bf16 v25, v23, s54, v25
  v_dot2_f32_bf16 v49, v47, s54, v49
  v_dot2_f32_bf16 v27, v23, v23, v27
  v_dot2_f32_bf16 v51, v47, v47, v51
  v_lshlrev_b32 v28, 16, v20
  v_lshlrev_b32 v52, 16, v44
  v_and_b32 v29, s55, v20
  v_and_b32 v53, s55, v44
  v_add_f32 v24, v24, v25
  v_add_f32 v48, v48, v49
  v_add_f32 v26, v26, v27
  v_add_f32 v50, v50, v51
  v_lshlrev_b32 v30, 16, v21
  v_lshlrev_b32 v54, 16, v45
  v_add_f32_dpp v24, v24, v24 quad_perm:[1,0,3,2] row_mask:0xf bank_mask:0xf
  v_add_f32_dpp v48, v48, v48 quad_perm:[1,0,3,2] row_mask:0xf bank_mask:0xf
  v_add_f32_dpp v26, v26, v26 quad_perm:[1,0,3,2] row_mask:0xf bank_mask:0xf
  v_add_f32_dpp v50, v50, v50 quad_perm:[1,0,3,2] row_mask:0xf bank_mask:0xf
  v_and_b32 v31, s55, v21
  v_and_b32 v55, s55, v45
  v_add_f32_dpp v24, v24, v24 quad_perm:[2,3,0,1] row_mask:0xf bank_mask:0xf
  v_add_f32_dpp v48, v48, v48 quad_perm:[2,3,0,1] row_mask:0xf bank_mask:0xf
  v_add_f32_dpp v26, v26, v26 quad_perm:[2,3,0,1] row_mask:0xf bank_mask:0xf
  v_add_f32_dpp v50, v50, v50 quad_perm:[2,3,0,1] row_mask:0xf bank_mask:0xf
  v_lshlrev_b32 v32, 16, v22
  v_lshlrev_b32 v56, 16, v46
  v_add_f32_dpp v24, v24, v24 row_half_mirror row_mask:0xf bank_mask:0xf
  v_add_f32_dpp v48, v48, v48 row_half_mirror row_mask:0xf bank_mask:0xf
  v_add_f32_dpp v26, v26, v26 row_half_mirror row_mask:0xf bank_mask:0xf
  v_add_f32_dpp v50, v50, v50 row_half_mirror row_mask:0xf bank_mask:0xf
  v_and_b32 v33, s55, v22
  v_and_b32 v57, s55, v46
  v_add_f32_dpp v24, v24, v24 row_mirror row_mask:0xf bank_mask:0xf
  v_add_f32_dpp v48, v48, v48 row_mirror row_mask:0xf bank_mask:0xf
  v_add_f32_dpp v26, v26, v26 row_mirror row_mask:0xf bank_mask:0xf
  v_add_f32_dpp v50, v50, v50 row_mirror row_mask:0xf bank_mask:0xf
  v_lshlrev_b32 v34, 16, v23
  v_lshlrev_b32 v58, 16, v47
  v_add_f32_dpp v24, v24, v24 row_bcast:15 row_mask:0xa bank_mask:0xf
  v_add_f32_dpp v48, v48, v48 row_bcast:15 row_mask:0xa bank_mask:0xf
  v_add_f32_dpp v26, v26, v26 row_bcast:15 row_mask:0xa bank_mask:0xf
  v_add_f32_dpp v50, v50, v50 row_bcast:15 row_mask:0xa bank_mask:0xf
  v_and_b32 v35, s55, v23
  v_and_b32 v59, s55, v47
  v_add_f32_dpp v24, v24, v24 row_bcast:31 row_mask:0xc bank_mask:0xf
  v_add_f32_dpp v48, v48, v48 row_bcast:31 row_mask:0xc bank_mask:0xf
  v_add_f32_dpp v26, v26, v26 row_bcast:31 row_mask:0xc bank_mask:0xf
  v_add_f32_dpp v50, v50, v50 row_bcast:31 row_mask:0xc bank_mask:0xf
  v_readlane_b32 s42, v24, 63
  v_readlane_b32 s24, v48, 63
  v_readlane_b32 s43, v26, 63
  v_readlane_b32 s25, v50, 63
  v_mov_b32 v24, 0x3b124925
  v_mov_b32 v48, 0x3b124925
  v_mul_f32 v26, s43, v24
  v_mul_f32 v50, s25, v48
  v_mul_f32 v24, s42, v24
  v_mul_f32 v48, s24, v48
  v_fma_f32 v26, -v24, v24, v26
  v_fma_f32 v50, -v48, v48, v50
  v_max_f32 v26, 0, v26
  v_max_f32 v50, 0, v50
  v_cvt_pk_bf16_f32 v25, v24, v26
  v_cvt_pk_bf16_f32 v49, v48, v50
  v_and_b32 v26, s55, v25
  v_and_b32 v50, s55, v49
  v_add_f32 v26, 0x3727c5ac, v26
  v_add_f32 v50, 0x3727c5ac, v50
  v_cvt_pk_bf16_f32 v26, v26, v26
  v_cvt_pk_bf16_f32 v50, v50, v50
  v_and_b32 v26, s55, v26
  v_and_b32 v50, s55, v50
  v_sqrt_f32 v26, v26
  v_sqrt_f32 v50, v50
  v_lshlrev_b32 v24, 16, v25
  v_lshlrev_b32 v48, 16, v49
  v_cvt_pk_bf16_f32 v25, v24, v26
  v_cvt_pk_bf16_f32 v49, v48, v50
  v_and_b32 v26, s55, v25
  v_and_b32 v50, s55, v49
  v_rcp_f32 v26, v26
  v_rcp_f32 v50, v50
  ds_write_b32 v138, v25 offset:0
  ds_write_b32 v138, v49 offset:16
  v_mul_f32 v27, -v24, v26
  v_mul_f32 v51, -v48, v50
  v_pk_fma_f32 v[28:29], v[28:29], v[26:27], v[26:27] op_sel:[0,0,1] op_sel_hi:[1,0,1]
  v_pk_fma_f32 v[52:53], v[52:53], v[50:51], v[50:51] op_sel:[0,0,1] op_sel_hi:[1,0,1]
  v_pk_fma_f32 v[30:31], v[30:31], v[26:27], v[26:27] op_sel:[0,0,1] op_sel_hi:[1,0,1]
  v_pk_fma_f32 v[54:55], v[54:55], v[50:51], v[50:51] op_sel:[0,0,1] op_sel_hi:[1,0,1]
  v_pk_fma_f32 v[32:33], v[32:33], v[26:27], v[26:27] op_sel:[0,0,1] op_sel_hi:[1,0,1]
  v_pk_fma_f32 v[56:57], v[56:57], v[50:51], v[50:51] op_sel:[0,0,1] op_sel_hi:[1,0,1]
  v_pk_fma_f32 v[34:35], v[34:35], v[26:27], v[26:27] op_sel:[0,0,1] op_sel_hi:[1,0,1]
  v_pk_fma_f32 v[58:59], v[58:59], v[50:51], v[50:51] op_sel:[0,0,1] op_sel_hi:[1,0,1]
  v_cvt_pk_bf16_f32 v36, v28, v29
  v_cvt_pk_bf16_f32 v60, v52, v53
  v_cvt_pk_bf16_f32 v37, v30, v31
  v_cvt_pk_bf16_f32 v61, v54, v55
  v_cvt_pk_bf16_f32 v38, v32, v33
  v_cvt_pk_bf16_f32 v62, v56, v57
  v_cvt_pk_bf16_f32 v39, v34, v35
  v_cvt_pk_bf16_f32 v63, v58, v59
  ds_write_b128 v137, v[36:39] offset:0
  ds_write_b128 v137, v[60:63] offset:3840
K1_LNC:
  s_cmp_lg_u32 s101, 0
  s_cbranch_scc1 K1_R3
  v_dot2_f32_bf16 v24, v20, s54, 0
  v_dot2_f32_bf16 v26, v20, v20, 0
  v_dot2_f32_bf16 v25, v21, s54, 0
  v_dot2_f32_bf16 v27, v21, v21, 0
  v_dot2_f32_bf16 v24, v22, s54, v24
  v_dot2_f32_bf16 v26, v22, v22, v26
  v_dot2_f32_bf16 v25, v23, s54, v25
  v_dot2_f32_bf16 v27, v23, v23, v27
  v_lshlrev_b32 v28, 16, v20
  v_and_b32 v29, s55, v20
  v_add_f32 v24, v24, v25
  v_add_f32 v26, v26, v27
  v_lshlrev_b32 v30, 16, v21
  v_add_f32_dpp v24, v24, v24 quad_perm:[1,0,3,2] row_mask:0xf bank_mask:0xf
  v_add_f32_dpp v26, v26, v26 quad_perm:[1,0,3,2] row_mask:0xf bank_mask:0xf
  v_and_b32 v31, s55, v21
  v_add_f32_dpp v24, v24, v24 quad_perm:[2,3,0,1] row_mask:0xf bank_mask:0xf
  v_add_f32_dpp v26, v26, v26 quad_perm:[2,3,0,1] row_mask:0xf bank_mask:0xf
  v_lshlrev_b32 v32, 16, v22
  v_add_f32_dpp v24, v24, v24 row_half_mirror row_mask:0xf bank_mask:0xf
  v_add_f32_dpp v26, v26, v26 row_half_mirror row_mask:0xf bank_mask:0xf
  v_and_b32 v33, s55, v22
  v_add_f32_dpp v24, v24, v24 row_mirror row_mask:0xf bank_mask:0xf
  v_add_f32_dpp v26, v26, v26 row_mirror row_mask:0xf bank_mask:0xf
  v_lshlrev_b32 v34, 16, v23
  v_add_f32_dpp v24, v24, v24 row_bcast:15 row_mask:0xa bank_mask:0xf
  v_add_f32_dpp v26, v26, v26 row_bcast:15 row_mask:0xa bank_mask:0xf
  v_and_b32 v35, s55, v23
  v_add_f32_dpp v24, v24, v24 row_bcast:31 row_mask:0xc bank_mask:0xf
  v_add_f32_dpp v26, v26, v26 row_bcast:31 row_mask:0xc bank_mask:0xf
  v_readlane_b32 s42, v24, 63
  v_readlane_b32 s43, v26, 63
  v_mov_b32 v24, 0x3b124925
  s_nop 0
  v_mul_f32 v26, s43, v24
  v_mul_f32 v24, s42, v24
  v_fma_f32 v26, -v24, v24, v26
  v_max_f32 v26, 0, v26
  v_cvt_pk_bf16_f32 v25, v24, v26
  v_and_b32 v26, s55, v25
  v_add_f32 v26, 0x3727c5ac, v26
  v_cvt_pk_bf16_f32 v26, v26, v26
  v_and_b32 v26, s55, v26
  v_sqrt_f32 v26, v26
  v_lshlrev_b32 v24, 16, v25
  v_cvt_pk_bf16_f32 v25, v24, v26
  v_and_b32 v26, s55, v25
  v_rcp_f32 v26, v26
  ds_write_b32 v138, v25 offset:0
  v_mul_f32 v27, -v24, v26
  v_pk_fma_f32 v[28:29], v[28:29], v[26:27], v[26:27] op_sel:[0,0,1] op_sel_hi:[1,0,1]
  v_pk_fma_f32 v[30:31], v[30:31], v[26:27], v[26:27] op_sel:[0,0,1] op_sel_hi:[1,0,1]
  v_pk_fma_f32 v[32:33], v[32:33], v[26:27], v[26:27] op_sel:[0,0,1] op_sel_hi:[1,0,1]
  v_pk_fma_f32 v[34:35], v[34:35], v[26:27], v[26:27] op_sel:[0,0,1] op_sel_hi:[1,0,1]
  v_cvt_pk_bf16_f32 v36, v28, v29
  v_cvt_pk_bf16_f32 v37, v30, v31
  v_cvt_pk_bf16_f32 v38, v32, v33
  v_cvt_pk_bf16_f32 v39, v34, v35
  ds_write_b128 v137, v[36:39] offset:0
  s_nop 0
K1_R3:
  s_waitcnt lgkmcnt(0)
  s_barrier
  ds_read_b64_tr_b16 v[24:25], v148
  ds_read_b64_tr_b16 v[26:27], v148 offset:3840
  ds_read_b128 v[252:255], v147
  s_cmp_eq_u32 s87, 7
  s_waitcnt lgkmcnt(1)
  s_cbranch_scc1 K1_LN7
  buffer_store_dwordx4 v[24:27], v139, s[28:31], s26 offen sc1
  s_cmp_ge_u32 s63, 64
  s_nop 0
  s_cbranch_scc1 K1_LN7
  ds_read_b64_tr_b16 v[28:29], v148 offset:8192
  v_lshlrev_b32 v30, 3, v1
  s_mul_i32 s26, s63, 3584
  s_lshl_b32 s61, s87, 9
  s_add_u32 s26, s26, s61
  s_add_u32 s26, s26, 1605632
  s_waitcnt lgkmcnt(0)
  buffer_store_dwordx2 v[28:29], v30, s[28:31], s26 offen sc1
K1_LN7:
  s_waitcnt vmcnt(7)
  v_mul_f32 v17, 0x3fb8aa00, v16
  v_exp_f32 v17, v17
  v_mul_f32 v18, 0x36a407db, v16
  v_fma_f32 v17, v17, v18, v17
  v_cvt_pk_bf16_f32 v17, v17, v17
  v_lshlrev_b32 v17, 16, v17
  v_mul_f32 v10, v17, v10
  v_mul_f32 v11, v17, v11
  v_mul_f32 v52, 0x3fb8aa3b, v10
  v_mul_f32 v53, 0x3e22f983, v11
  v_mul_f32 v54, 0x42b8aa3b, v10
  v_mul_f32 v55, 0x4122f983, v11
  v_fract_f32 v53, v53
  v_fract_f32 v55, v55
  v_exp_f32 v52, v52
  v_cos_f32 v20, v53
  v_sin_f32 v21, v53
  v_exp_f32 v54, v54
  v_cos_f32 v40, v55
  v_sin_f32 v41, v55
  v_mul_f32 v20, v52, v20
  v_mul_f32 v21, v52, v21
  v_mul_f32 v40, v54, v40
  v_mul_f32 v41, v54, v41
  s_waitcnt lgkmcnt(0)
  buffer_load_dword v164, v165, s[56:59], 0 offen sc1
  s_mov_b32 s16, 0
  v_pk_mul_f32 v[22:23], v[20:21], v[20:21] op_sel:[0,0] op_sel_hi:[0,1]
  v_pk_fma_f32 v[22:23], v[20:21], v[20:21], v[22:23] op_sel:[1,1,0] op_sel_hi:[1,0,1] neg_lo:[0,1,0]
  v_pk_mul_f32 v[38:39], v[40:41], v[40:41] op_sel:[0,0] op_sel_hi:[0,1]
  v_pk_fma_f32 v[38:39], v[40:41], v[40:41], v[38:39] op_sel:[1,1,0] op_sel_hi:[1,0,1] neg_lo:[0,1,0]
  v_cvt_pk_bf16_f32 v88, v22, -v23
  ds_write_addtid_b32 v88 offset:2112
  v_pk_mul_f32 v[26:27], v[22:23], v[22:23] op_sel:[0,0] op_sel_hi:[0,1]
  v_pk_fma_f32 v[26:27], v[22:23], v[22:23], v[26:27] op_sel:[1,1,0] op_sel_hi:[1,0,1] neg_lo:[0,1,0]
  v_cvt_pk_bf16_f32 v90, v20, -v21
  v_pk_mul_f32 v[44:45], v[38:39], v[38:39] op_sel:[0,0] op_sel_hi:[0,1]
  ds_write_addtid_b32 v90 offset:1056
  v_pk_fma_f32 v[44:45], v[38:39], v[38:39], v[44:45] op_sel:[1,1,0] op_sel_hi:[1,0,1] neg_lo:[0,1,0]
  v_cvt_pk_bf16_f32 v91, v26, -v27
  v_pk_mul_f32 v[34:35], v[26:27], v[26:27] op_sel:[0,0] op_sel_hi:[0,1]
  ds_write_addtid_b32 v91 offset:4224
  v_pk_fma_f32 v[34:35], v[26:27], v[26:27], v[34:35] op_sel:[1,1,0] op_sel_hi:[1,0,1] neg_lo:[0,1,0]
  v_cvt_pk_bf16_f32 v88, v44, -v45
  v_pk_mul_f32 v[42:43], v[38:39], v[40:41] op_sel:[0,0] op_sel_hi:[0,1]
  ds_write_addtid_b32 v88 offset:8448
  v_pk_fma_f32 v[42:43], v[38:39], v[40:41], v[42:43] op_sel:[1,1,0] op_sel_hi:[1,0,1] neg_lo:[0,1,0]
  v_pk_mul_f32 v[24:25], v[22:23], v[20:21] op_sel:[0,0] op_sel_hi:[0,1]
  v_pk_fma_f32 v[24:25], v[22:23], v[20:21], v[24:25] op_sel:[1,1,0] op_sel_hi:[1,0,1] neg_lo:[0,1,0]
  v_pk_mul_f32 v[46:47], v[44:45], v[44:45] op_sel:[0,0] op_sel_hi:[0,1]
  v_pk_fma_f32 v[46:47], v[44:45], v[44:45], v[46:47] op_sel:[1,1,0] op_sel_hi:[1,0,1] neg_lo:[0,1,0]
  v_cvt_pk_bf16_f32 v91, v24, -v25
  v_pk_mul_f32 v[30:31], v[26:27], v[22:23] op_sel:[0,0] op_sel_hi:[0,1]
  ds_write_addtid_b32 v91 offset:3168
  v_pk_fma_f32 v[30:31], v[26:27], v[22:23], v[30:31] op_sel:[1,1,0] op_sel_hi:[1,0,1] neg_lo:[0,1,0]
  v_cvt_pk_bf16_f32 v88, v46, -v47
  v_pk_mul_f32 v[56:57], v[26:27], v[20:21] op_sel:[0,0] op_sel_hi:[0,1]
  ds_write_addtid_b32 v88 offset:12672
  v_pk_fma_f32 v[56:57], v[26:27], v[20:21], v[56:57] op_sel:[1,1,0] op_sel_hi:[1,0,1] neg_lo:[0,1,0]
  v_cvt_pk_bf16_f32 v89, v30, -v31
  s_waitcnt vmcnt(3)
  ds_write_addtid_b32 v89 offset:6336
  s_cmp_gt_u32 s50, 2
  s_cbranch_scc1 K1_AV1
  s_getreg_b32 s51, hwreg(HW_REG_IB_STS, 0, 4)
  s_cmp_gt_u32 s51, s16
  s_cbranch_scc1 K1_AV1
  s_call_b64 s[48:49], K1_ADV
K1_AV1:
  v_mul_f32 v12, v17, v12
  v_mul_f32 v13, v17, v13
  v_cvt_pk_bf16_f32 v90, v56, -v57
  v_pk_mul_f32 v[64:65], v[14:15], v[12:13] op_sel:[0,0] op_sel_hi:[0,1]
  ds_write_addtid_b32 v90 offset:5280
  v_pk_fma_f32 v[64:65], v[14:15], v[12:13], v[64:65] op_sel:[1,1,0] op_sel_hi:[1,0,1] neg_lo:[0,1,0]
  v_pk_mul_f32 v[66:67], v[64:65], v[34:35] op_sel:[0,0] op_sel_hi:[0,1]
  v_pk_fma_f32 v[66:67], v[64:65], v[34:35], v[66:67] op_sel:[1,1,0] op_sel_hi:[1,0,1] neg_lo:[0,1,0]
  v_cvt_pk_bf16_f32 v88, v64, v65
  v_pk_mul_f32 v[56:57], v[64:65], v[40:41] op_sel:[0,0] op_sel_hi:[0,1]
  ds_write_addtid_b32 v88 offset:22176
  v_pk_fma_f32 v[56:57], v[64:65], v[40:41], v[56:57] op_sel:[1,1,0] op_sel_hi:[1,0,1] neg_lo:[0,1,0]
  v_cvt_pk_bf16_f32 v89, v66, v67
  v_pk_mul_f32 v[58:59], v[64:65], v[38:39] op_sel:[0,0] op_sel_hi:[0,1]
  ds_write_addtid_b32 v89 offset:23232
  v_pk_fma_f32 v[58:59], v[64:65], v[38:39], v[58:59] op_sel:[1,1,0] op_sel_hi:[1,0,1] neg_lo:[0,1,0]
  v_cvt_pk_bf16_f32 v90, v56, v57
  v_pk_mul_f32 v[52:53], v[64:65], v[42:43] op_sel:[0,0] op_sel_hi:[0,1]
  ds_write_addtid_b32 v90 offset:30624
  v_pk_fma_f32 v[52:53], v[64:65], v[42:43], v[52:53] op_sel:[1,1,0] op_sel_hi:[1,0,1] neg_lo:[0,1,0]
  v_cvt_pk_bf16_f32 v91, v58, v59
  v_pk_mul_f32 v[50:51], v[46:47], v[46:47] op_sel:[0,0] op_sel_hi:[0,1]
  ds_write_addtid_b32 v91 offset:39072
  v_pk_fma_f32 v[50:51], v[46:47], v[46:47], v[50:51] op_sel:[1,1,0] op_sel_hi:[1,0,1] neg_lo:[0,1,0]
  v_cvt_pk_bf16_f32 v88, v52, v53
  v_pk_mul_f32 v[68:69], v[66:67], v[34:35] op_sel:[0,0] op_sel_hi:[0,1]
  ds_write_addtid_b32 v88 offset:47520
  v_pk_fma_f32 v[68:69], v[66:67], v[34:35], v[68:69] op_sel:[1,1,0] op_sel_hi:[1,0,1] neg_lo:[0,1,0]
  v_cvt_pk_bf16_f32 v89, v50, -v51
  v_pk_mul_f32 v[58:59], v[66:67], v[40:41] op_sel:[0,0] op_sel_hi:[0,1]
  ds_write_addtid_b32 v89 offset:16896
  v_pk_fma_f32 v[58:59], v[66:67], v[40:41], v[58:59] op_sel:[1,1,0] op_sel_hi:[1,0,1] neg_lo:[0,1,0]
  v_cvt_pk_bf16_f32 v90, v68, v69
  v_pk_mul_f32 v[52:53], v[66:67], v[38:39] op_sel:[0,0] op_sel_hi:[0,1]
  ds_write_addtid_b32 v90 offset:24288
  v_pk_fma_f32 v[52:53], v[66:67], v[38:39], v[52:53] op_sel:[1,1,0] op_sel_hi:[1,0,1] neg_lo:[0,1,0]
  s_cmp_gt_u32 s50, 2
  s_cbranch_scc1 K1_AV2
  s_getreg_b32 s51, hwreg(HW_REG_IB_STS, 0, 4)
  s_cmp_gt_u32 s51, s16
  s_cbranch_scc1 K1_AV2
  s_call_b64 s[48:49], K1_ADV
K1_AV2:
  s_cmp_ge_u32 s87, 4
  s_nop 0
  s_cbranch_scc1 K1_HF2
  s_lshl2_add_u32 s25, s2, s87
  s_mul_i32 s24, s25, 1792
  s_and_b32 s25, s25, -2
  s_mul_i32 s25, s25, 1792
  v_min_u32 v146, 27, v1
  v_lshl_add_u32 v146, v146, 7, s25
  global_load_dword v149, v146, s[80:81]
  v_min_u32 v146, 13, v1
  v_lshl_add_u32 v146, v146, 7, s24
  global_load_dword v149, v146, s[94:95]
  s_add_u32 s16, s16, 2
K1_HF2:
  v_cvt_pk_bf16_f32 v91, v58, v59
  v_pk_mul_f32 v[54:55], v[66:67], v[42:43] op_sel:[0,0] op_sel_hi:[0,1]
  ds_write_addtid_b32 v91 offset:31680
  v_pk_fma_f32 v[54:55], v[66:67], v[42:43], v[54:55] op_sel:[1,1,0] op_sel_hi:[1,0,1] neg_lo:[0,1,0]
  v_cvt_pk_bf16_f32 v88, v52, v53
  v_pk_mul_f32 v[48:49], v[46:47], v[44:45] op_sel:[0,0] op_sel_hi:[0,1]
  ds_write_addtid_b32 v88 offset:40128
  v_pk_fma_f32 v[48:49], v[46:47], v[44:45], v[48:49] op_sel:[1,1,0] op_sel_hi:[1,0,1] neg_lo:[0,1,0]
  v_cvt_pk_bf16_f32 v89, v54, v55
  v_pk_mul_f32 v[58:59], v[26:27], v[24:25] op_sel:[0,0] op_sel_hi:[0,1]
  ds_write_addtid_b32 v89 offset:48576
  v_pk_fma_f32 v[58:59], v[26:27], v[24:25], v[58:59] op_sel:[1,1,0] op_sel_hi:[1,0,1] neg_lo:[0,1,0]
  v_cvt_pk_bf16_f32 v90, v48, -v49
  v_pk_mul_f32 v[70:71], v[68:69], v[34:35] op_sel:[0,0] op_sel_hi:[0,1]
  ds_write_addtid_b32 v90 offset:14784
K1C_H0:
  s_cbranch_execz K1C_H1
  s_nop 0
  v_pk_fma_f32 v[70:71], v[68:69], v[34:35], v[70:71] op_sel:[1,1,0] op_sel_hi:[1,0,1] neg_lo:[0,1,0]
  v_cvt_pk_bf16_f32 v91, v58, -v59
  v_pk_mul_f32 v[54:55], v[68:69], v[40:41] op_sel:[0,0] op_sel_hi:[0,1]
  ds_write_addtid_b32 v91 offset:7392
  v_pk_fma_f32 v[54:55], v[68:69], v[40:41], v[54:55] op_sel:[1,1,0] op_sel_hi:[1,0,1] neg_lo:[0,1,0]
  v_cvt_pk_bf16_f32 v88, v70, v71
  v_pk_mul_f32 v[56:57], v[68:69], v[38:39] op_sel:[0,0] op_sel_hi:[0,1]
  ds_write_addtid_b32 v88 offset:25344
  v_pk_fma_f32 v[56:57], v[68:69], v[38:39], v[56:57] op_sel:[1,1,0] op_sel_hi:[1,0,1] neg_lo:[0,1,0]
  v_cvt_pk_bf16_f32 v89, v54, v55
  v_pk_mul_f32 v[58:59], v[68:69], v[42:43] op_sel:[0,0] op_sel_hi:[0,1]
  ds_write_addtid_b32 v89 offset:32736
  v_pk_fma_f32 v[58:59], v[68:69], v[42:43], v[58:59] op_sel:[1,1,0] op_sel_hi:[1,0,1] neg_lo:[0,1,0]
  v_cvt_pk_bf16_f32 v90, v56, v57
  v_pk_mul_f32 v[52:53], v[44:45], v[22:23] op_sel:[0,0] op_sel_hi:[0,1]
  ds_write_addtid_b32 v90 offset:41184
  v_pk_fma_f32 v[52:53], v[44:45], v[22:23], v[52:53] op_sel:[1,1,0] op_sel_hi:[1,0,1] neg_lo:[0,1,0]
  v_cvt_pk_bf16_f32 v91, v58, v59
  v_pk_mul_f32 v[72:73], v[70:71], v[34:35] op_sel:[0,0] op_sel_hi:[0,1]
  ds_write_addtid_b32 v91 offset:49632
  v_pk_fma_f32 v[72:73], v[70:71], v[34:35], v[72:73] op_sel:[1,1,0] op_sel_hi:[1,0,1] neg_lo:[0,1,0]
  s_cmp_gt_u32 s50, 2
  s_cbranch_scc1 K1_AV3
  s_getreg_b32 s51, hwreg(HW_REG_IB_STS, 0, 4)
  s_cmp_gt_u32 s51, s16
  s_cbranch_scc1 K1_AV3
  s_call_b64 s[48:49], K1_ADV
K1_AV3:
  v_cvt_pk_bf16_f32 v88, v52, -v53
  v_pk_mul_f32 v[56:57], v[70:71], v[40:41] op_sel:[0,0] op_sel_hi:[0,1]
  ds_write_addtid_b32 v88 offset:9504
  v_pk_fma_f32 v[56:57], v[70:71], v[40:41], v[56:57] op_sel:[1,1,0] op_sel_hi:[1,0,1] neg_lo:[0,1,0]
  v_cvt_pk_bf16_f32 v89, v72, v73
  v_pk_mul_f32 v[58:59], v[70:71], v[38:39] op_sel:[0,0] op_sel_hi:[0,1]
  ds_write_addtid_b32 v89 offset:26400
  v_pk_fma_f32 v[58:59], v[70:71], v[38:39], v[58:59] op_sel:[1,1,0] op_sel_hi:[1,0,1] neg_lo:[0,1,0]
  v_cvt_pk_bf16_f32 v90, v56, v57
  v_pk_mul_f32 v[52:53], v[70:71], v[42:43] op_sel:[0,0] op_sel_hi:[0,1]
  ds_write_addtid_b32 v90 offset:33792
  v_pk_fma_f32 v[52:53], v[70:71], v[42:43], v[52:53] op_sel:[1,1,0] op_sel_hi:[1,0,1] neg_lo:[0,1,0]
  v_cvt_pk_bf16_f32 v91, v58, v59
  v_pk_mul_f32 v[54:55], v[44:45], v[26:27] op_sel:[0,0] op_sel_hi:[0,1]
  ds_write_addtid_b32 v91 offset:42240
  v_pk_fma_f32 v[54:55], v[44:45], v[26:27], v[54:55] op_sel:[1,1,0] op_sel_hi:[1,0,1] neg_lo:[0,1,0]
  v_cvt_pk_bf16_f32 v88, v52, v53
  v_pk_mul_f32 v[56:57], v[44:45], v[30:31] op_sel:[0,0] op_sel_hi:[0,1]
  ds_write_addtid_b32 v88 offset:50688
  v_pk_fma_f32 v[56:57], v[44:45], v[30:31], v[56:57] op_sel:[1,1,0] op_sel_hi:[1,0,1] neg_lo:[0,1,0]
  v_cvt_pk_bf16_f32 v89, v54, -v55
  v_pk_mul_f32 v[74:75], v[72:73], v[34:35] op_sel:[0,0] op_sel_hi:[0,1]
  ds_write_addtid_b32 v89 offset:10560
  v_pk_fma_f32 v[74:75], v[72:73], v[34:35], v[74:75] op_sel:[1,1,0] op_sel_hi:[1,0,1] neg_lo:[0,1,0]
  v_cvt_pk_bf16_f32 v90, v56, -v57
  v_pk_mul_f32 v[52:53], v[72:73], v[40:41] op_sel:[0,0] op_sel_hi:[0,1]
  ds_write_addtid_b32 v90 offset:11616
  v_pk_fma_f32 v[52:53], v[72:73], v[40:41], v[52:53] op_sel:[1,1,0] op_sel_hi:[1,0,1] neg_lo:[0,1,0]
  v_cvt_pk_bf16_f32 v91, v74, v75
  v_pk_mul_f32 v[54:55], v[72:73], v[38:39] op_sel:[0,0] op_sel_hi:[0,1]
  ds_write_addtid_b32 v91 offset:27456
  v_pk_fma_f32 v[54:55], v[72:73], v[38:39], v[54:55] op_sel:[1,1,0] op_sel_hi:[1,0,1] neg_lo:[0,1,0]
  v_cvt_pk_bf16_f32 v88, v52, v53
  v_pk_mul_f32 v[56:57], v[72:73], v[42:43] op_sel:[0,0] op_sel_hi:[0,1]
  ds_write_addtid_b32 v88 offset:34848
  v_pk_fma_f32 v[56:57], v[72:73], v[42:43], v[56:57] op_sel:[1,1,0] op_sel_hi:[1,0,1] neg_lo:[0,1,0]
  s_cmp_gt_u32 s50, 2
  s_cbranch_scc1 K1_AV4
  s_getreg_b32 s51, hwreg(HW_REG_IB_STS, 0, 4)
  s_cmp_gt_u32 s51, s16
  s_cbranch_scc1 K1_AV4
  s_call_b64 s[48:49], K1_ADV
K1_AV4:
  v_cvt_pk_bf16_f32 v89, v54, v55
  v_pk_mul_f32 v[58:59], v[46:47], v[26:27] op_sel:[0,0] op_sel_hi:[0,1]
  ds_write_addtid_b32 v89 offset:43296
  v_pk_fma_f32 v[58:59], v[46:47], v[26:27], v[58:59] op_sel:[1,1,0] op_sel_hi:[1,0,1] neg_lo:[0,1,0]
  v_cvt_pk_bf16_f32 v90, v56, v57
  v_pk_mul_f32 v[76:77], v[74:75], v[34:35] op_sel:[0,0] op_sel_hi:[0,1]
  ds_write_addtid_b32 v90 offset:51744
  v_pk_fma_f32 v[76:77], v[74:75], v[34:35], v[76:77] op_sel:[1,1,0] op_sel_hi:[1,0,1] neg_lo:[0,1,0]
  v_cvt_pk_bf16_f32 v91, v58, -v59
  v_pk_mul_f32 v[54:55], v[74:75], v[40:41] op_sel:[0,0] op_sel_hi:[0,1]
  ds_write_addtid_b32 v91 offset:13728
  v_pk_fma_f32 v[54:55], v[74:75], v[40:41], v[54:55] op_sel:[1,1,0] op_sel_hi:[1,0,1] neg_lo:[0,1,0]
  v_cvt_pk_bf16_f32 v88, v76, v77
  v_pk_mul_f32 v[56:57], v[74:75], v[38:39] op_sel:[0,0] op_sel_hi:[0,1]
  ds_write_addtid_b32 v88 offset:28512
  v_pk_fma_f32 v[56:57], v[74:75], v[38:39], v[56:57] op_sel:[1,1,0] op_sel_hi:[1,0,1] neg_lo:[0,1,0]
  v_cvt_pk_bf16_f32 v89, v54, v55
  v_pk_mul_f32 v[58:59], v[74:75], v[42:43] op_sel:[0,0] op_sel_hi:[0,1]
  ds_write_addtid_b32 v89 offset:35904
  v_pk_fma_f32 v[58:59], v[74:75], v[42:43], v[58:59] op_sel:[1,1,0] op_sel_hi:[1,0,1] neg_lo:[0,1,0]
  v_cvt_pk_bf16_f32 v90, v56, v57
  v_pk_mul_f32 v[52:53], v[48:49], v[26:27] op_sel:[0,0] op_sel_hi:[0,1]
  ds_write_addtid_b32 v90 offset:44352
  v_pk_fma_f32 v[52:53], v[48:49], v[26:27], v[52:53] op_sel:[1,1,0] op_sel_hi:[1,0,1] neg_lo:[0,1,0]
  v_cvt_pk_bf16_f32 v91, v58, v59
  v_pk_mul_f32 v[54:55], v[50:51], v[44:45] op_sel:[0,0] op_sel_hi:[0,1]
  ds_write_addtid_b32 v91 offset:52800
  v_pk_fma_f32 v[54:55], v[50:51], v[44:45], v[54:55] op_sel:[1,1,0] op_sel_hi:[1,0,1] neg_lo:[0,1,0]
  v_cvt_pk_bf16_f32 v88, v52, -v53
  v_pk_mul_f32 v[78:79], v[76:77], v[34:35] op_sel:[0,0] op_sel_hi:[0,1]
  ds_write_addtid_b32 v88 offset:15840
  v_pk_fma_f32 v[78:79], v[76:77], v[34:35], v[78:79] op_sel:[1,1,0] op_sel_hi:[1,0,1] neg_lo:[0,1,0]
  v_cvt_pk_bf16_f32 v89, v54, -v55
  v_pk_mul_f32 v[58:59], v[76:77], v[40:41] op_sel:[0,0] op_sel_hi:[0,1]
  ds_write_addtid_b32 v89 offset:17952
  v_pk_fma_f32 v[58:59], v[76:77], v[40:41], v[58:59] op_sel:[1,1,0] op_sel_hi:[1,0,1] neg_lo:[0,1,0]
  s_cmp_gt_u32 s50, 2
  s_cbranch_scc1 K1_AV5
  s_getreg_b32 s51, hwreg(HW_REG_IB_STS, 0, 4)
  s_cmp_gt_u32 s51, s16
  s_cbranch_scc1 K1_AV5
  s_call_b64 s[48:49], K1_ADV
K1_AV5:
  v_cvt_pk_bf16_f32 v90, v78, v79
  v_pk_mul_f32 v[52:53], v[76:77], v[38:39] op_sel:[0,0] op_sel_hi:[0,1]
  ds_write_addtid_b32 v90 offset:29568
  v_pk_fma_f32 v[52:53], v[76:77], v[38:39], v[52:53] op_sel:[1,1,0] op_sel_hi:[1,0,1] neg_lo:[0,1,0]
  v_cvt_pk_bf16_f32 v91, v58, v59
  v_pk_mul_f32 v[54:55], v[76:77], v[42:43] op_sel:[0,0] op_sel_hi:[0,1]
  ds_write_addtid_b32 v91 offset:36960
  v_pk_fma_f32 v[54:55], v[76:77], v[42:43], v[54:55] op_sel:[1,1,0] op_sel_hi:[1,0,1] neg_lo:[0,1,0]
  v_cvt_pk_bf16_f32 v88, v52, v53
  v_pk_mul_f32 v[56:57], v[50:51], v[46:47] op_sel:[0,0] op_sel_hi:[0,1]
  ds_write_addtid_b32 v88 offset:45408
  v_pk_fma_f32 v[56:57], v[50:51], v[46:47], v[56:57] op_sel:[1,1,0] op_sel_hi:[1,0,1] neg_lo:[0,1,0]
  v_cvt_pk_bf16_f32 v89, v54, v55
  v_pk_mul_f32 v[58:59], v[78:79], v[40:41] op_sel:[0,0] op_sel_hi:[0,1]
  ds_write_addtid_b32 v89 offset:53856
  v_pk_fma_f32 v[58:59], v[78:79], v[40:41], v[58:59] op_sel:[1,1,0] op_sel_hi:[1,0,1] neg_lo:[0,1,0]
  v_cvt_pk_bf16_f32 v90, v56, -v57
  v_pk_mul_f32 v[52:53], v[78:79], v[38:39] op_sel:[0,0] op_sel_hi:[0,1]
  ds_write_addtid_b32 v90 offset:19008
  v_pk_fma_f32 v[52:53], v[78:79], v[38:39], v[52:53] op_sel:[1,1,0] op_sel_hi:[1,0,1] neg_lo:[0,1,0]
  v_cvt_pk_bf16_f32 v91, v58, v59
  v_pk_mul_f32 v[54:55], v[78:79], v[42:43] op_sel:[0,0] op_sel_hi:[0,1]
  ds_write_addtid_b32 v91 offset:38016
  v_pk_fma_f32 v[54:55], v[78:79], v[42:43], v[54:55] op_sel:[1,1,0] op_sel_hi:[1,0,1] neg_lo:[0,1,0]
  v_cvt_pk_bf16_f32 v88, v52, v53
  v_pk_mul_f32 v[56:57], v[50:51], v[48:49] op_sel:[0,0] op_sel_hi:[0,1]
  ds_write_addtid_b32 v88 offset:46464
  v_pk_fma_f32 v[56:57], v[50:51], v[48:49], v[56:57] op_sel:[1,1,0] op_sel_hi:[1,0,1] neg_lo:[0,1,0]
  v_cvt_pk_bf16_f32 v89, v54, v55
  v_pk_mul_f32 v[58:59], v[50:51], v[50:51] op_sel:[0,0] op_sel_hi:[0,1]
  ds_write_addtid_b32 v89 offset:54912
  v_pk_fma_f32 v[58:59], v[50:51], v[50:51], v[58:59] op_sel:[1,1,0] op_sel_hi:[1,0,1] neg_lo:[0,1,0]
  v_cvt_pk_bf16_f32 v90, v56, -v57
  ds_write_addtid_b32 v90 offset:20064
  v_cvt_pk_bf16_f32 v91, v58, -v59
  ds_write_addtid_b32 v91 offset:21120
  s_cmp_gt_u32 s50, 2
  s_cbranch_scc1 K1_AV6
  s_getreg_b32 s51, hwreg(HW_REG_IB_STS, 0, 4)
  s_cmp_gt_u32 s51, s16
  s_cbranch_scc1 K1_AV6
  s_call_b64 s[48:49], K1_ADV
K1_AV6:
  s_cmp_ge_u32 s87, 4
  s_cbranch_scc1 K1_HF3
  s_waitcnt vmcnt(8)
  s_add_u32 m0, s86, 147456
  s_add_u32 s85, s84, 0
  buffer_load_dwordx4 v240, s[80:83], s85 offen lds
  s_add_u32 s85, s85, 13312
  buffer_load_dwordx4 v240, s[80:83], s85 offen offset:1024 lds
  s_add_i32 m0, m0, 4096
  s_add_i32 s85, s85, 44032
  buffer_load_dwordx4 v240, s[80:83], s85 offen lds
  s_add_u32 s85, s85, 13312
  buffer_load_dwordx4 v240, s[80:83], s85 offen offset:1024 lds
  s_add_u32 s16, s16, 4
  s_mov_b32 m0, s6
  s_nop 0
K1_HF3:
  s_cmp_ge_u32 s87, 4
  s_cbranch_scc1 K1_KH
  s_cmp_lg_u32 s50, 0
  s_cbranch_scc1 K1_TW1
  s_waitcnt vmcnt(7)
K1_TW1:
  s_lshl2_add_u32 s44, s4, 129856
  v_mov_b32 v52, s50
  v_mov_b32 v53, s44
  ds_write_b32 v53, v52
  s_mov_b32 s50, 5
  s_waitcnt lgkmcnt(0)
  s_barrier
  ds_read_b128 v[52:55], v107 offset:22176
  ds_read_b128 v[56:59], v105 offset:0
  ds_read_b128 v[60:63], v106 offset:16896
  ds_read_b128 v[64:67], v107 offset:22240
  ds_read_b128 v[68:71], v105 offset:64
  ds_read_b128 v[72:75], v106 offset:16960
  ds_read_b128 v[76:79], v107 offset:22304
  ds_read_b128 v[80:83], v105 offset:128
  ds_read_b128 v[84:87], v106 offset:17024
  ds_read_b128 v[88:91], v107 offset:22368
  ds_read_b128 v[92:95], v105 offset:192
  ds_read_b128 v[96:99], v106 offset:17088
  ds_read_b128 v[20:23], v107 offset:22432
  ds_read_b128 v[24:27], v105 offset:256
  ds_read_b128 v[28:31], v106 offset:17152
  s_waitcnt lgkmcnt(12)
  v_mfma_f32_16x16x32_bf16 v[112:115], v[52:55], v[56:59], 0
  v_mfma_f32_16x16x32_bf16 v[32:35], v[52:55], v[60:63], 0
  ds_read_b128 v[116:119], v107 offset:22496
  ds_read_b128 v[120:123], v105 offset:320
  ds_read_b128 v[124:127], v106 offset:17216
  s_waitcnt lgkmcnt(12)
  v_mfma_f32_16x16x32_bf16 v[112:115], v[64:67], v[68:71], v[112:115]
  v_mfma_f32_16x16x32_bf16 v[32:35], v[64:67], v[72:75], v[32:35]
  ds_read_b128 v[52:55], v107 offset:22560
  ds_read_b128 v[56:59], v105 offset:384
  ds_read_b128 v[60:63], v106 offset:17280
  s_waitcnt lgkmcnt(12)
  v_mfma_f32_16x16x32_bf16 v[112:115], v[76:79], v[80:83], v[112:115]
  v_mfma_f32_16x16x32_bf16 v[32:35], v[76:79], v[84:87], v[32:35]
  ds_read_b128 v[64:67], v107 offset:22624
  ds_read_b128 v[68:71], v105 offset:448
  ds_read_b128 v[72:75], v106 offset:17344
  s_waitcnt lgkmcnt(12)
  v_mfma_f32_16x16x32_bf16 v[112:115], v[88:91], v[92:95], v[112:115]
  v_mfma_f32_16x16x32_bf16 v[32:35], v[88:91], v[96:99], v[32:35]
  ds_read_b128 v[76:79], v107 offset:22688
  ds_read_b128 v[80:83], v105 offset:512
  ds_read_b128 v[84:87], v106 offset:17408
  s_waitcnt lgkmcnt(12)
  v_mfma_f32_16x16x32_bf16 v[112:115], v[20:23], v[24:27], v[112:115]
  v_mfma_f32_16x16x32_bf16 v[32:35], v[20:23], v[28:31], v[32:35]
  ds_read_b128 v[88:91], v107 offset:22752
  ds_read_b128 v[92:95], v105 offset:576
  ds_read_b128 v[96:99], v106 offset:17472
  s_waitcnt lgkmcnt(12)
  v_mfma_f32_16x16x32_bf16 v[112:115], v[116:119], v[120:123], v[112:115]
  v_mfma_f32_16x16x32_bf16 v[32:35], v[116:119], v[124:127], v[32:35]
  ds_read_b128 v[20:23], v107 offset:22816
  ds_read_b128 v[24:27], v105 offset:640
  ds_read_b128 v[28:31], v106 offset:17536
  v_mad_u32_u16 v40, v128, 1, s40 op_sel:[1,0,0,0]
  v_mad_u32_u16 v41, v129, 1, s40
  s_waitcnt lgkmcnt(12)
  v_mfma_f32_16x16x32_bf16 v[112:115], v[52:55], v[56:59], v[112:115]
  v_mfma_f32_16x16x32_bf16 v[32:35], v[52:55], v[60:63], v[32:35]
  ds_read_b128 v[116:119], v107 offset:22880
  ds_read_b128 v[120:123], v105 offset:704
  ds_read_b128 v[124:127], v106 offset:17600
  v_mad_u32_u16 v42, v129, 1, s40 op_sel:[1,0,0,0]
  v_mad_u32_u16 v43, v100, 1, s40
  s_waitcnt lgkmcnt(12)
  v_mfma_f32_16x16x32_bf16 v[112:115], v[64:67], v[68:71], v[112:115]
  v_mfma_f32_16x16x32_bf16 v[32:35], v[64:67], v[72:75], v[32:35]
  ds_read_b128 v[52:55], v107 offset:22944
  ds_read_b128 v[56:59], v105 offset:768
  ds_read_b128 v[60:63], v106 offset:17664
  v_mad_u32_u16 v44, v100, 1, s40 op_sel:[1,0,0,0]
  v_mad_u32_u16 v45, v101, 1, s40
  s_waitcnt lgkmcnt(12)
  v_mfma_f32_16x16x32_bf16 v[112:115], v[76:79], v[80:83], v[112:115]
  v_mfma_f32_16x16x32_bf16 v[32:35], v[76:79], v[84:87], v[32:35]
  ds_read_b128 v[64:67], v107 offset:23008
  ds_read_b128 v[68:71], v105 offset:832
  ds_read_b128 v[72:75], v106 offset:17728
  v_mad_u32_u16 v46, v101, 1, s40 op_sel:[1,0,0,0]
  v_mad_u32_u16 v47, v102, 1, s40
  s_waitcnt lgkmcnt(12)
  v_mfma_f32_16x16x32_bf16 v[112:115], v[88:91], v[92:95], v[112:115]
  v_mfma_f32_16x16x32_bf16 v[32:35], v[88:91], v[96:99], v[32:35]
  ds_read_b128 v[76:79], v107 offset:23072
  ds_read_b128 v[80:83], v105 offset:896
  ds_read_b128 v[84:87], v106 offset:17792
  v_mad_u32_u16 v48, v102, 1, s40 op_sel:[1,0,0,0]
  v_mad_u32_u16 v49, v103, 1, s40
  s_waitcnt lgkmcnt(12)
  v_mfma_f32_16x16x32_bf16 v[112:115], v[20:23], v[24:27], v[112:115]
  v_mfma_f32_16x16x32_bf16 v[32:35], v[20:23], v[28:31], v[32:35]
  ds_read_b128 v[88:91], v107 offset:23136
  ds_read_b128 v[92:95], v105 offset:960
  ds_read_b128 v[96:99], v106 offset:17856
  v_mad_u32_u16 v50, v103, 1, s40 op_sel:[1,0,0,0]
  s_add_u32 s9, s8, 4080
  s_waitcnt lgkmcnt(12)
  v_mfma_f32_16x16x32_bf16 v[112:115], v[116:119], v[120:123], v[112:115]
  v_mfma_f32_16x16x32_bf16 v[32:35], v[116:119], v[124:127], v[32:35]
  v_sub_u32 v18, s9, v19
  v_cmp_eq_u32 vcc, 0, v0
  s_waitcnt lgkmcnt(9)
  v_mfma_f32_16x16x32_bf16 v[112:115], v[52:55], v[56:59], v[112:115]
  v_mfma_f32_16x16x32_bf16 v[32:35], v[52:55], v[60:63], v[32:35]
  v_mov_b32 v36, 0
  v_mov_b32 v37, 0
  s_waitcnt lgkmcnt(6)
  v_mfma_f32_16x16x32_bf16 v[112:115], v[64:67], v[68:71], v[112:115]
  v_mfma_f32_16x16x32_bf16 v[32:35], v[64:67], v[72:75], v[32:35]
  v_mov_b32 v38, 0
  v_mov_b32 v39, 0
  s_waitcnt lgkmcnt(3)
  v_mfma_f32_16x16x32_bf16 v[112:115], v[76:79], v[80:83], v[112:115]
  v_mfma_f32_16x16x32_bf16 v[32:35], v[76:79], v[84:87], v[32:35]
  v_cndmask_b32 v9, 0, v9, vcc
  v_lshl_add_u32 v104, v0, 2, s8
  s_waitcnt lgkmcnt(0)
  v_mfma_f32_16x16x32_bf16 v[112:115], v[88:91], v[92:95], v[112:115]
  v_mfma_f32_16x16x32_bf16 v[32:35], v[88:91], v[96:99], v[32:35]
  v_add_u32 v10, s8, v19
  v_mov_b32 v11, s8
  s_nop 4
  ds_write_b128 v109, v[112:115]
  ds_write_b128 v109, v[32:35] offset:2304
  s_waitcnt lgkmcnt(0)
  s_branch K1_KE
K1_KH:
  s_waitcnt lgkmcnt(0)
  s_barrier
  ds_read_b32 v52, v138 offset:10176
  s_waitcnt lgkmcnt(0)
  v_readfirstlane_b32 s44, v52
  s_nop 0
  s_cmp_eq_u32 s44, 5
  s_nop 2
  s_cbranch_scc1 K1_HO
  s_cmp_eq_u32 s50, 3
  s_cselect_b32 s10, 0, s10
  s_or_b32 s10, s10, 0x4c
  s_and_b32 s10, s10, s12
  s_min_u32 s50, s50, 2
K1_HO:
  s_cmp_gt_u32 s50, 2
  s_cbranch_scc1 K1_AV7
  s_getreg_b32 s51, hwreg(HW_REG_IB_STS, 0, 4)
  s_cmp_gt_u32 s51, s16
  s_cbranch_scc1 K1_AV7
  s_call_b64 s[48:49], K1_ADV
K1_AV7:
  s_cmp_lg_u32 s50, 0
  s_cbranch_scc1 K1_TW2
  s_waitcnt vmcnt(1)
K1_TW2:
  v_mad_u32_u16 v40, v128, 1, s40 op_sel:[1,0,0,0]
  v_mad_u32_u16 v41, v129, 1, s40
  v_mad_u32_u16 v42, v129, 1, s40 op_sel:[1,0,0,0]
  v_mad_u32_u16 v43, v100, 1, s40
  v_mad_u32_u16 v44, v100, 1, s40 op_sel:[1,0,0,0]
  v_mad_u32_u16 v45, v101, 1, s40
  v_mad_u32_u16 v46, v101, 1, s40 op_sel:[1,0,0,0]
  v_mad_u32_u16 v47, v102, 1, s40
  v_mad_u32_u16 v48, v102, 1, s40 op_sel:[1,0,0,0]
  v_mad_u32_u16 v49, v103, 1, s40
  v_mad_u32_u16 v50, v103, 1, s40 op_sel:[1,0,0,0]
  s_add_u32 s9, s8, 4080
  v_sub_u32 v18, s9, v19
  v_cmp_eq_u32 vcc, 0, v0
  v_mov_b32 v36, 0
  v_mov_b32 v37, 0
  v_mov_b32 v38, 0
  v_mov_b32 v39, 0
  v_cndmask_b32 v9, 0, v9, vcc
  v_lshl_add_u32 v104, v0, 2, s8
  v_add_u32 v10, s8, v19
  v_mov_b32 v11, s8
  s_waitcnt vmcnt(8)
  s_add_u32 m0, s86, 131072
  s_add_u32 s85, s84, 114688
  buffer_load_dwordx4 v240, s[80:83], s85 offen lds
  s_add_u32 s85, s85, 13312
  buffer_load_dwordx4 v240, s[80:83], s85 offen offset:1024 lds
  s_add_i32 m0, m0, -4096
  s_add_i32 s85, s85, -70656
  buffer_load_dwordx4 v240, s[80:83], s85 offen lds
  s_add_u32 s85, s85, 13312
  buffer_load_dwordx4 v240, s[80:83], s85 offen offset:1024 lds
  s_add_u32 s16, s16, 4
  s_sleep 3
  s_cmp_gt_u32 s50, 4
  s_cbranch_scc1 K1_AV8
  s_getreg_b32 s51, hwreg(HW_REG_IB_STS, 0, 4)
  s_cmp_gt_u32 s51, s16
  s_cbranch_scc1 K1_AV8
  s_call_b64 s[48:49], K1_ADV
K1_AV8:
K1_KE:
  s_barrier
  s_cmp_gt_u32 s50, 4
  s_cbranch_scc1 K1_AV9
  s_getreg_b32 s51, hwreg(HW_REG_IB_STS, 0, 4)
  s_cmp_gt_u32 s51, s16
  s_cbranch_scc1 K1_AV9
  s_call_b64 s[48:49], K1_ADV
K1_AV9:
  ds_read_b32 v40, v40
  ds_read_b32 v41, v41
  ds_read_b32 v42, v42
  ds_read_b32 v43, v43
  ds_read_b32 v44, v44
  ds_read_b32 v45, v45
  ds_read_b32 v46, v46
  ds_read_b32 v47, v47
  ds_read_b32 v48, v48
  ds_read_b32 v49, v49
  ds_read_b32 v50, v50
  ds_write_b128 v136, v[36:39]
  s_cmp_gt_u32 s50, 4
  s_cbranch_scc1 K1_AV10
  s_getreg_b32 s51, hwreg(HW_REG_IB_STS, 0, 4)
  s_cmp_gt_u32 s51, s16
  s_cbranch_scc1 K1_AV10
  s_call_b64 s[48:49], K1_ADV
K1_AV10:
  s_cmp_ge_u32 s87, 4
  s_cbranch_scc1 K1_HF4
  s_waitcnt vmcnt(8)
  s_add_u32 m0, s86, 65536
  s_add_u32 s85, s84, 229376
  buffer_load_dwordx4 v240, s[80:83], s85 offen lds
  s_add_u32 s85, s85, 13312
  buffer_load_dwordx4 v240, s[80:83], s85 offen offset:1024 lds
  s_add_i32 m0, m0, 4096
  s_add_i32 s85, s85, 44032
  buffer_load_dwordx4 v240, s[80:83], s85 offen lds
  s_add_u32 s85, s85, 13312
  buffer_load_dwordx4 v240, s[80:83], s85 offen offset:1024 lds
  s_add_u32 s16, s16, 4
K1_HF4:
  s_waitcnt lgkmcnt(1)
  v_cndmask_b32 v40, v40, 0, vcc
  v_cndmask_b32 v41, v41, 0, vcc
  v_cndmask_b32 v42, v42, 0, vcc
  v_add_f32 v43, v43, v9
  s_cmp_gt_u32 s50, 4
  s_cbranch_scc1 K1_AV11
  s_getreg_b32 s51, hwreg(HW_REG_IB_STS, 0, 4)
  s_cmp_gt_u32 s51, s16
  s_cbranch_scc1 K1_AV11
  s_call_b64 s[48:49], K1_ADV
K1_AV11:
  v_cvt_pk_bf16_f32 v56, v50, v49
  v_add_f32 v217, v43, v44
  v_cvt_pk_bf16_f32 v57, v48, v47
  v_add_f32 v218, v217, v45
  v_cvt_pk_bf16_f32 v58, v46, v45
  v_add_f32 v219, v218, v46
  s_cmp_gt_u32 s50, 4
  s_cbranch_scc1 K1_AV12
  s_getreg_b32 s51, hwreg(HW_REG_IB_STS, 0, 4)
  s_cmp_gt_u32 s51, s16
  s_cbranch_scc1 K1_AV12
  s_call_b64 s[48:49], K1_ADV
K1_AV12:
  v_cvt_pk_bf16_f32 v59, v44, v43
  v_add_f32 v220, v219, v47
  ds_write_b128 v18, v[56:59] offset:0
  v_add_f32 v221, v220, v48
  v_cvt_pk_bf16_f32 v60, v49, v48
  v_add_f32 v222, v221, v49
  s_cmp_gt_u32 s50, 4
  s_cbranch_scc1 K1_AV13
  s_getreg_b32 s51, hwreg(HW_REG_IB_STS, 0, 4)
  s_cmp_gt_u32 s51, s16
  s_cbranch_scc1 K1_AV13
  s_call_b64 s[48:49], K1_ADV
K1_AV13:
  v_cvt_pk_bf16_f32 v61, v47, v46
  v_add_f32 v223, v222, v50
  v_cvt_pk_bf16_f32 v62, v45, v44
  v_mov_b32 v88, v223
  v_cvt_pk_bf16_f32 v63, v43, v42
  v_mov_b32 v216, v43
  ds_write_b128 v18, v[60:63] offset:4160
  s_cmp_gt_u32 s50, 4
  s_cbranch_scc1 K1_AV14
  s_getreg_b32 s51, hwreg(HW_REG_IB_STS, 0, 4)
  s_cmp_gt_u32 s51, s16
  s_cbranch_scc1 K1_AV14
  s_call_b64 s[48:49], K1_ADV
K1_AV14:
  v_add_f32_dpp v88, v88, v88 row_shr:1 row_mask:0xf bank_mask:0xf bound_ctrl:0
  v_cvt_pk_bf16_f32 v64, v48, v47
  v_cvt_pk_bf16_f32 v65, v46, v45
  v_add_f32_dpp v88, v88, v88 row_shr:2 row_mask:0xf bank_mask:0xf bound_ctrl:0
  v_cvt_pk_bf16_f32 v66, v44, v43
  v_cvt_pk_bf16_f32 v67, v42, v41
  v_add_f32_dpp v88, v88, v88 row_shr:4 row_mask:0xf bank_mask:0xf bound_ctrl:0
  ds_write_b128 v18, v[64:67] offset:8320
  v_cvt_pk_bf16_f32 v68, v47, v46
  v_add_f32_dpp v88, v88, v88 row_shr:8 row_mask:0xf bank_mask:0xf bound_ctrl:0
  v_cvt_pk_bf16_f32 v69, v45, v44
  v_cvt_pk_bf16_f32 v70, v43, v42
  v_add_f32_dpp v88, v88, v88 row_bcast:15 row_mask:0xa bank_mask:0xf
  v_cvt_pk_bf16_f32 v71, v41, v40
  ds_write_b128 v18, v[68:71] offset:12480
  v_add_f32_dpp v88, v88, v88 row_bcast:31 row_mask:0xc bank_mask:0xf
  ds_write_b32 v104, v88 offset:29696
  v_sub_f32 v15, v88, v223
  s_cmp_gt_u32 s50, 4
  s_cbranch_scc1 K1_AV15
  s_getreg_b32 s51, hwreg(HW_REG_IB_STS, 0, 4)
  s_cmp_gt_u32 s51, s16
  s_cbranch_scc1 K1_AV15
  s_call_b64 s[48:49], K1_ADV
K1_AV15:
  s_movk_i32 s63, 6000
  s_nop 0
K1_W2:
  s_cmp_eq_u32 s50, 5
  s_cbranch_scc1 K1_W9
  s_waitcnt vmcnt(0)
  s_call_b64 s[48:49], K1_ADV
  s_sub_u32 s63, s63, 1
  s_cbranch_scc1 K1_W9
  s_bitcmp1_b32 0x34, s50
  s_cbranch_scc1 K1_W2
  s_sleep 8
  s_branch K1_W2
K1_W9:
  s_waitcnt vmcnt(0)
  s_cmp_lt_u32 s87, 4
  s_cbranch_scc1 K1_HF5
  s_waitcnt vmcnt(0)
  ds_write_b128 v151, v[156:159] offset:17152
  ds_write_b128 v151, v[160:163] offset:17664
K1_HF5:
  s_setprio 2
  s_waitcnt lgkmcnt(0)
  s_barrier
  s_cmp_ge_u32 s87, 4
  s_cbranch_scc1 K1_HF6
  buffer_load_dwordx4 v[228:231], v166, s[28:31], s60 offen sc1
  buffer_load_dwordx4 v[232:235], v166, s[28:31], s60 offen offset:16 sc1
K1_HF6:
  s_cmp_lt_u32 s87, 4
  s_cbranch_scc1 K1_HF7
  s_add_u32 m0, s86, 81920
  s_add_u32 s85, s84, 344064
  buffer_load_dwordx4 v240, s[80:83], s85 offen lds
  s_add_u32 s85, s85, 13312
  buffer_load_dwordx4 v240, s[80:83], s85 offen offset:1024 lds
  s_add_u32 m0, s86, 98304
  s_add_u32 s85, s84, 458752
  buffer_load_dwordx4 v240, s[80:83], s85 offen lds
  s_add_u32 s85, s85, 13312
  buffer_load_dwordx4 v240, s[80:83], s85 offen offset:1024 lds
  s_add_u32 m0, s86, 114688
  s_add_u32 s85, s84, 573440
  buffer_load_dwordx4 v240, s[80:83], s85 offen lds
  s_add_u32 s85, s85, 13312
  buffer_load_dwordx4 v240, s[80:83], s85 offen offset:1024 lds
  buffer_store_dwordx4 v[244:247], v250, s[28:31], s35 offen sc1
  buffer_store_dwordx4 v[244:247], v250, s[28:31], s34 offen sc1
  s_nop 1
K1_HF7:
  ds_read_b64 v[56:57], v236 offset:3648
  ds_read_b64 v[58:59], v236 offset:3656
  ds_read_b128 v[88:91], v237 offset:64
  ds_read_b64 v[60:61], v236 offset:3136
  ds_read_b64 v[62:63], v236 offset:3144
  ds_read_b128 v[92:95], v237 offset:576
  ds_read_b64 v[64:65], v236 offset:2624
  ds_read_b64 v[66:67], v236 offset:2632
  ds_read_b128 v[96:99], v237 offset:1088
  ds_read_b64 v[68:69], v236 offset:2112
  ds_read_b64 v[70:71], v236 offset:2120
  ds_read_b128 v[100:103], v237 offset:1600
  s_waitcnt lgkmcnt(9)
  v_mfma_f32_16x16x32_bf16 v[24:27], v[56:59], v[88:91], 0
  ds_read_b64 v[72:73], v236 offset:1600
  ds_read_b64 v[74:75], v236 offset:1608
  s_waitcnt lgkmcnt(8)
  v_mfma_f32_16x16x32_bf16 v[28:31], v[60:63], v[88:91], 0
  ds_read_b128 v[104:107], v237 offset:2112
  ds_read_b64 v[76:77], v236 offset:1088
  v_mfma_f32_16x16x32_bf16 v[32:35], v[60:63], v[92:95], 0
  ds_read_b64 v[78:79], v236 offset:1096
  ds_read_b128 v[108:111], v237 offset:2624
  v_mfma_f32_16x16x32_bf16 v[28:31], v[56:59], v[92:95], v[28:31]
  ds_read_b64 v[80:81], v236 offset:576
  ds_read_b64 v[82:83], v236 offset:584
  s_waitcnt lgkmcnt(11)
  v_mfma_f32_16x16x32_bf16 v[32:35], v[64:67], v[88:91], v[32:35]
  ds_read_b128 v[112:115], v237 offset:3136
  ds_read_b64 v[84:85], v236 offset:64
  v_mfma_f32_16x16x32_bf16 v[36:39], v[64:67], v[92:95], 0
  ds_read_b64 v[86:87], v236 offset:72
  ds_read_b128 v[116:119], v237 offset:3648
  v_mfma_f32_16x16x32_bf16 v[40:43], v[64:67], v[96:99], 0
  ds_read_b32 v12, v11 offset:29948
  ds_read_b32 v13, v11 offset:30204
  v_mfma_f32_16x16x32_bf16 v[32:35], v[56:59], v[96:99], v[32:35]
  ds_read_b32 v14, v11 offset:30460
  ds_read_b128 v[224:227], v10 offset:17152
  v_mfma_f32_16x16x32_bf16 v[36:39], v[60:63], v[96:99], v[36:39]
  ds_read_b64 v[120:121], v236 offset:3584
  ds_read_b64 v[122:123], v236 offset:3592
  s_waitcnt lgkmcnt(15)
  v_mfma_f32_16x16x32_bf16 v[36:39], v[68:71], v[88:91], v[36:39]
  ds_read_b128 v[144:147], v237 offset:0
  ds_read_b64 v[124:125], v236 offset:3072
  v_mfma_f32_16x16x32_bf16 v[40:43], v[68:71], v[92:95], v[40:43]
  ds_read_b64 v[126:127], v236 offset:3080
  ds_read_b128 v[148:151], v237 offset:512
  v_mfma_f32_16x16x32_bf16 v[44:47], v[68:71], v[96:99], 0
  ds_read_b64 v[128:129], v236 offset:2560
  ds_read_b64 v[130:131], v236 offset:2568
  v_mfma_f32_16x16x32_bf16 v[48:51], v[68:71], v[100:103], 0
  ds_read_b128 v[152:155], v237 offset:1024
  ds_read_b64 v[132:133], v236 offset:2048
  s_mul_i32 s47, s87, 448
  s_add_u32 s47, s47, s62
  v_mfma_f32_16x16x32_bf16 v[36:39], v[56:59], v[100:103], v[36:39]
  ds_read_b64 v[134:135], v236 offset:2056
  ds_read_b128 v[156:159], v237 offset:1536
  s_lshr_b32 s47, s47, 1
  s_lshl_b32 s47, s47, 6
  v_mfma_f32_16x16x32_bf16 v[40:43], v[60:63], v[100:103], v[40:43]
  ds_read_b64 v[136:137], v236 offset:1536
  ds_read_b64 v[138:139], v236 offset:1544
  s_add_u32 s47, s47, 12967936
  s_lshl_b32 s9, s2, 7
  v_mfma_f32_16x16x32_bf16 v[44:47], v[64:67], v[100:103], v[44:47]
  ds_read_b128 v[160:163], v237 offset:2048
  ds_read_b64 v[140:141], v236 offset:1024
  s_add_u32 s9, s9, 12918784
  v_mov_b32 v249, s47
  v_mfma_f32_16x16x32_bf16 v[40:43], v[72:75], v[88:91], v[40:43]
  ds_read_b64 v[142:143], v236 offset:1032
  ds_read_b128 v[164:167], v237 offset:2560
  v_writelane_b32 v249, s9, 1
  s_lshr_b32 s9, s2, 5
  v_mfma_f32_16x16x32_bf16 v[44:47], v[72:75], v[92:95], v[44:47]
  ds_read_b64_tr_b16 v[168:169], v242 offset:32768
  ds_read_b64_tr_b16 v[170:171], v242 offset:33792
  s_lshl_b32 s47, s87, 3
  s_add_u32 s9, s9, s47
  v_mfma_f32_16x16x32_bf16 v[48:51], v[72:75], v[96:99], v[48:51]
  ds_read_b64_tr_b16 v[172:173], v242 offset:36864
  ds_read_b64_tr_b16 v[174:175], v242 offset:37888
  s_cmp_eq_u32 s9, 2
  s_cselect_b32 s46, 3, 1
  s_mov_b32 s47, 0
  v_mfma_f32_16x16x32_bf16 v[52:55], v[72:75], v[100:103], 0
  ds_read_b64_tr_b16 v[176:177], v242 offset:16384
K1C_H1:
  s_cbranch_execz K1C_HE
  s_nop 0
  ds_read_b64_tr_b16 v[178:179], v242 offset:17408
  s_waitcnt lgkmcnt(15)
  v_mov_b32 v208, 0x3f80
  v_mfma_f32_16x16x32_bf16 v[40:43], v[56:59], v[104:107], v[40:43]
  ds_read_b64_tr_b16 v[180:181], v242 offset:20480
  ds_read_b64_tr_b16 v[182:183], v242 offset:21504
  v_fmac_f32 v15, s37, v12
  v_fmac_f32 v15, s38, v13
  v_mfma_f32_16x16x32_bf16 v[44:47], v[60:63], v[104:107], v[44:47]
  ds_read_b64_tr_b16 v[184:185], v241 offset:0
  ds_read_b64_tr_b16 v[186:187], v241 offset:1024
  v_fmac_f32 v15, s39, v14
  v_lshl_or_b32 v192, v224, 16, v208
  v_mfma_f32_16x16x32_bf16 v[48:51], v[64:67], v[104:107], v[48:51]
  ds_read_b64_tr_b16 v[188:189], v241 offset:4096
  ds_read_b64_tr_b16 v[190:191], v241 offset:5120
  v_lshl_or_b32 v194, v225, 16, v208
  v_lshl_or_b32 v196, v226, 16, v208
  v_mfma_f32_16x16x32_bf16 v[52:55], v[68:71], v[104:107], v[52:55]
  v_lshl_or_b32 v198, v227, 16, v208
  v_and_or_b32 v193, v224, s55, v208
  v_mfma_f32_16x16x32_bf16 v[44:47], v[76:79], v[88:91], v[44:47]
  v_and_or_b32 v195, v225, s55, v208
  v_and_or_b32 v197, v226, s55, v208
  v_mfma_f32_16x16x32_bf16 v[48:51], v[76:79], v[92:95], v[48:51]
  v_and_or_b32 v199, v227, s55, v208
  v_add_f32 v216, v216, v15
  v_mfma_f32_16x16x32_bf16 v[52:55], v[76:79], v[96:99], v[52:55]
  v_add_f32 v217, v217, v15
  v_add_f32 v218, v218, v15
  v_mfma_f32_16x16x32_bf16 v[44:47], v[56:59], v[108:111], v[44:47]
  v_add_f32 v219, v219, v15
  v_add_f32 v220, v220, v15
  v_mfma_f32_16x16x32_bf16 v[48:51], v[60:63], v[108:111], v[48:51]
  v_add_f32 v221, v221, v15
  v_add_f32 v222, v222, v15
  v_mfma_f32_16x16x32_bf16 v[52:55], v[64:67], v[108:111], v[52:55]
  v_add_f32 v223, v223, v15
  v_mfma_f32_16x16x32_bf16 v[48:51], v[80:83], v[88:91], v[48:51]
  ds_read_b64 v[72:73], v236 offset:512
  ds_read_b64 v[74:75], v236 offset:520
  v_mfma_f32_16x16x32_bf16 v[52:55], v[80:83], v[92:95], v[52:55]
  ds_read_b128 v[104:107], v237 offset:3072
  ds_read_b64 v[76:77], v236 offset:0
  v_mfma_f32_16x16x32_bf16 v[48:51], v[56:59], v[112:115], v[48:51]
  ds_read_b64 v[78:79], v236 offset:8
  ds_read_b128 v[108:111], v237 offset:3584
  v_mfma_f32_16x16x32_bf16 v[52:55], v[60:63], v[112:115], v[52:55]
  v_mfma_f32_16x16x32_bf16 v[52:55], v[84:87], v[88:91], v[52:55]
  v_mfma_f32_16x16x32_bf16 v[52:55], v[56:59], v[116:119], v[52:55]
  v_mov_b32 v20, 1
  buffer_load_dword v20, v251, s[28:31], s33 offen sc1
  s_cmp_ge_u32 s87, 4
  s_nop 4
  s_cbranch_scc1 K1_HF8
  s_add_u32 m0, s86, 81920
  s_add_u32 s85, s84, 344064
  buffer_load_dwordx4 v240, s[80:83], s85 offen lds
  s_add_u32 s85, s85, 13312
  buffer_load_dwordx4 v240, s[80:83], s85 offen offset:1024 lds
  s_add_u32 m0, s86, 98304
  s_add_u32 s85, s84, 458752
  buffer_load_dwordx4 v240, s[80:83], s85 offen lds
  s_add_u32 s85, s85, 13312
  buffer_load_dwordx4 v240, s[80:83], s85 offen offset:1024 lds
  s_add_u32 m0, s86, 114688
  s_add_u32 s85, s84, 573440
  buffer_load_dwordx4 v240, s[80:83], s85 offen lds
  s_add_u32 s85, s85, 13312
  buffer_load_dwordx4 v240, s[80:83], s85 offen offset:1024 lds
  buffer_store_dwordx4 v[244:247], v250, s[28:31], s35 offen sc1
  buffer_store_dwordx4 v[244:247], v250, s[28:31], s34 offen sc1
  s_nop 1
K1_HF8:
  s_waitcnt vmcnt(9)
  v_dot2_f32_bf16 v200, v192, v228, 0
  v_dot2_f32_bf16 v201, v193, v229, 0
  v_dot2_f32_bf16 v202, v194, v230, 0
  v_dot2_f32_bf16 v203, v195, v231, 0
  v_dot2_f32_bf16 v204, v196, v232, 0
  v_dot2_f32_bf16 v205, v197, v233, 0
  v_dot2_f32_bf16 v206, v198, v234, 0
  v_dot2_f32_bf16 v207, v199, v235, 0
  s_waitcnt lgkmcnt(0)
  s_barrier
  s_waitcnt vmcnt(9)
  s_cmp_lt_u32 s87, 4
  s_cbranch_scc1 K1_HF9
  s_add_u32 m0, s86, 147456
  s_add_u32 s85, s88, 0
  s_sub_u32 s17, s85, 688128
  s_min_u32 s85, s85, s17
  s_add_u32 s85, s85, s90
  buffer_load_dwordx4 v240, s[80:83], s85 offen lds
  s_add_u32 s85, s85, 13312
  buffer_load_dwordx4 v240, s[80:83], s85 offen offset:1024 lds
  s_add_u32 m0, s86, 131072
  s_add_u32 s85, s88, 114688
  s_sub_u32 s17, s85, 688128
  s_min_u32 s85, s85, s17
  s_add_u32 s85, s85, s90
  buffer_load_dwordx4 v240, s[80:83], s85 offen lds
  s_add_u32 s85, s85, 13312
  buffer_load_dwordx4 v240, s[80:83], s85 offen offset:1024 lds
  s_add_u32 m0, s86, 65536
  s_add_u32 s85, s88, 229376
  s_sub_u32 s17, s85, 688128
  s_min_u32 s85, s85, s17
  s_add_u32 s85, s85, s90
  buffer_load_dwordx4 v240, s[80:83], s85 offen lds
  s_add_u32 s85, s85, 13312
  buffer_load_dwordx4 v240, s[80:83], s85 offen offset:1024 lds
K1_HF9:
  v_mfma_f32_16x16x32_bf16 v[24:27], v[120:123], v[144:147], v[24:27]
  v_mfma_f32_16x16x32_bf16 v[28:31], v[120:123], v[148:151], v[28:31]
  v_mfma_f32_16x16x32_bf16 v[28:31], v[124:127], v[144:147], v[28:31]
  v_mfma_f32_16x16x32_bf16 v[32:35], v[120:123], v[152:155], v[32:35]
  v_mfma_f32_16x16x32_bf16 v[32:35], v[124:127], v[148:151], v[32:35]
  s_nop 3
  ds_write_b128 v239, v[24:27] offset:0
  v_mfma_f32_16x16x32_bf16 v[32:35], v[128:131], v[144:147], v[32:35]
  v_mfma_f32_16x16x32_bf16 v[36:39], v[120:123], v[156:159], v[36:39]
  v_mfma_f32_16x16x32_bf16 v[36:39], v[124:127], v[152:155], v[36:39]
  v_mfma_f32_16x16x32_bf16 v[36:39], v[128:131], v[148:151], v[36:39]
  v_mfma_f32_16x16x32_bf16 v[36:39], v[132:135], v[144:147], v[36:39]
  ds_write_b128 v239, v[28:31] offset:1024
  v_mfma_f32_16x16x32_bf16 v[40:43], v[120:123], v[160:163], v[40:43]
  v_mfma_f32_16x16x32_bf16 v[40:43], v[124:127], v[156:159], v[40:43]
  v_mfma_f32_16x16x32_bf16 v[40:43], v[128:131], v[152:155], v[40:43]
  v_mfma_f32_16x16x32_bf16 v[40:43], v[132:135], v[148:151], v[40:43]
  v_mfma_f32_16x16x32_bf16 v[40:43], v[136:139], v[144:147], v[40:43]
  ds_write_b128 v239, v[32:35] offset:2048
  v_mfma_f32_16x16x32_bf16 v[44:47], v[120:123], v[164:167], v[44:47]
  v_mfma_f32_16x16x32_bf16 v[44:47], v[124:127], v[160:163], v[44:47]
  v_mfma_f32_16x16x32_bf16 v[44:47], v[128:131], v[156:159], v[44:47]
  v_mfma_f32_16x16x32_bf16 v[44:47], v[132:135], v[152:155], v[44:47]
  v_mfma_f32_16x16x32_bf16 v[44:47], v[136:139], v[148:151], v[44:47]
  ds_write_b128 v239, v[36:39] offset:3072
  v_mfma_f32_16x16x32_bf16 v[44:47], v[140:143], v[144:147], v[44:47]
  v_mfma_f32_16x16x32_bf16 v[48:51], v[120:123], v[104:107], v[48:51]
  s_waitcnt vmcnt(6)
  v_and_b32 v2, 1, v20
  v_cmp_ne_u32 vcc, 1, v2
  v_mfma_f32_16x16x32_bf16 v[48:51], v[124:127], v[164:167], v[48:51]
  s_nop 0
  s_nop 0
  v_mfma_f32_16x16x32_bf16 v[48:51], v[128:131], v[160:163], v[48:51]
  s_cbranch_vccnz K1_MSLOW
K1_MOK:
  v_cvt_pk_bf16_f32 v84, v20, v20
  v_mfma_f32_16x16x32_bf16 v[48:51], v[132:135], v[156:159], v[48:51]
  v_lshlrev_b32 v84, 16, v84
  v_add_f32 v85, 1.0, v84
  ds_write_b128 v239, v[40:43] offset:4096
  v_mfma_f32_16x16x32_bf16 v[48:51], v[136:139], v[152:155], v[48:51]
  v_cvt_pk_bf16_f32 v85, v85, v85
  v_lshlrev_b32 v85, 16, v85
  v_mfma_f32_16x16x32_bf16 v[48:51], v[140:143], v[148:151], v[48:51]
  v_readlane_b32 s40, v84, 0
  v_readlane_b32 s42, v84, 4
  v_mfma_f32_16x16x32_bf16 v[48:51], v[72:75], v[144:147], v[48:51]
  v_readlane_b32 s41, v85, 2
  v_readlane_b32 s43, v85, 8
  v_mfma_f32_16x16x32_bf16 v[52:55], v[120:123], v[108:111], v[52:55]
  v_mov_b32 v83, s42
  v_mul_f32 v84, s40, v83
  v_mfma_f32_16x16x32_bf16 v[52:55], v[124:127], v[104:107], v[52:55]
  v_mul_f32 v80, s41, v83
  v_mul_f32 v81, s41, v83
  ds_write_b128 v239, v[44:47] offset:5120
  v_mfma_f32_16x16x32_bf16 v[52:55], v[128:131], v[164:167], v[52:55]
  v_mov_b32 v82, s43
  v_mov_b32 v83, s43
  v_mfma_f32_16x16x32_bf16 v[52:55], v[132:135], v[160:163], v[52:55]
  v_fmac_f32 v200, v84, v216
  v_fmac_f32 v201, v84, v217
  v_mfma_f32_16x16x32_bf16 v[52:55], v[136:139], v[156:159], v[52:55]
  v_fmac_f32 v202, v84, v218
  v_fmac_f32 v203, v84, v219
  v_mfma_f32_16x16x32_bf16 v[52:55], v[140:143], v[152:155], v[52:55]
  v_fmac_f32 v204, v84, v220
  v_fmac_f32 v205, v84, v221
  v_mfma_f32_16x16x32_bf16 v[52:55], v[72:75], v[148:151], v[52:55]
  v_fmac_f32 v206, v84, v222
  v_fmac_f32 v207, v84, v223
  ds_write_b128 v239, v[48:51] offset:6144
  v_mfma_f32_16x16x32_bf16 v[52:55], v[76:79], v[144:147], v[52:55]
  s_nop 7
  ds_write_b128 v239, v[52:55] offset:7168
  s_cmp_ge_u32 s87, 4
  s_cbranch_scc1 K1_HF10
  s_add_u32 m0, s86, 147456
  s_add_u32 s85, s88, 0
  s_sub_u32 s17, s85, 688128
  s_min_u32 s85, s85, s17
  s_add_u32 s85, s85, s90
  buffer_load_dwordx4 v240, s[80:83], s85 offen lds
  s_add_u32 s85, s85, 13312
  buffer_load_dwordx4 v240, s[80:83], s85 offen offset:1024 lds
  s_add_u32 m0, s86, 131072
  s_add_u32 s85, s88, 114688
  s_sub_u32 s17, s85, 688128
  s_min_u32 s85, s85, s17
  s_add_u32 s85, s85, s90
  buffer_load_dwordx4 v240, s[80:83], s85 offen lds
  s_add_u32 s85, s85, 13312
  buffer_load_dwordx4 v240, s[80:83], s85 offen offset:1024 lds
  s_add_u32 m0, s86, 65536
  s_add_u32 s85, s88, 229376
  s_sub_u32 s17, s85, 688128
  s_min_u32 s85, s85, s17
  s_add_u32 s85, s85, s90
  buffer_load_dwordx4 v240, s[80:83], s85 offen lds
  s_add_u32 s85, s85, 13312
  buffer_load_dwordx4 v240, s[80:83], s85 offen offset:1024 lds
K1_HF10:
  s_waitcnt vmcnt(6) lgkmcnt(0)
  s_barrier
  ds_read_b128 v[24:27], v238 offset:0
  ds_read_b128 v[28:31], v238 offset:256
  ds_read_b128 v[32:35], v238 offset:8192
  ds_read_b128 v[36:39], v238 offset:8448
  ds_read_b128 v[40:43], v238 offset:16384
  ds_read_b128 v[44:47], v238 offset:16640
  ds_read_b128 v[48:51], v238 offset:24576
  ds_read_b128 v[52:55], v238 offset:24832
  s_mov_b64 exec, s[46:47]
  buffer_store_dword v244, v249, s[28:31], 0 offen sc1
  s_mov_b64 exec, -1
  s_waitcnt lgkmcnt(4)
  v_pk_add_f32 v[24:25], v[24:25], v[32:33]
  v_pk_add_f32 v[26:27], v[26:27], v[34:35]
  v_pk_add_f32 v[28:29], v[28:29], v[36:37]
  v_pk_add_f32 v[30:31], v[30:31], v[38:39]
  s_waitcnt lgkmcnt(0)
  v_pk_add_f32 v[40:41], v[40:41], v[48:49]
  v_pk_add_f32 v[42:43], v[42:43], v[50:51]
  v_pk_add_f32 v[44:45], v[44:45], v[52:53]
  v_pk_add_f32 v[46:47], v[46:47], v[54:55]
  v_pk_add_f32 v[24:25], v[24:25], v[40:41]
  v_pk_add_f32 v[26:27], v[26:27], v[42:43]
  v_pk_add_f32 v[28:29], v[28:29], v[44:45]
  v_pk_add_f32 v[30:31], v[30:31], v[46:47]
  v_pk_fma_f32 v[96:97], v[80:81], v[24:25], v[200:201]
  v_pk_fma_f32 v[98:99], v[80:81], v[26:27], v[202:203]
  v_pk_fma_f32 v[100:101], v[80:81], v[28:29], v[204:205]
  v_pk_fma_f32 v[102:103], v[80:81], v[30:31], v[206:207]
  v_pk_mul_f32 v[56:57], v[82:83], v[96:97]
  v_pk_mul_f32 v[58:59], v[82:83], v[98:99]
  v_pk_mul_f32 v[60:61], v[82:83], v[100:101]
  v_pk_mul_f32 v[62:63], v[82:83], v[102:103]
  v_cvt_pk_bf16_f32 v16, v56, v57
  v_cvt_pk_bf16_f32 v17, v58, v59
  v_cvt_pk_bf16_f32 v18, v60, v61
  v_cvt_pk_bf16_f32 v19, v62, v63
  buffer_store_dwordx4 v[16:19], v250, s[28:31], s35 offen sc1
  v_cvt_pk_bf16_f32 v12, v96, v97
  v_cvt_pk_bf16_f32 v13, v98, v99
  v_cvt_pk_bf16_f32 v14, v100, v101
  v_cvt_pk_bf16_f32 v15, v102, v103
  buffer_store_dwordx4 v[12:15], v250, s[28:31], s34 offen sc1
  s_nop 1
  s_branch K1_P2
K1_ADV:
  s_cmp_eq_u32 s50, 4
  s_cbranch_scc1 K1_AD4
  s_cmp_eq_u32 s50, 3
  s_cbranch_scc1 K1_AD3
  s_cmp_eq_u32 s50, 1
  s_cbranch_scc1 K1_AD1
  v_cmp_ne_u32 s[44:45], -1, v164
  s_nop 0
  s_and_b32 s44, s44, 0xf7f
  s_cselect_b32 s51, 1, s18
  s_cmp_gt_u32 s50, s51
  s_mov_b32 s50, s51
  s_cbranch_scc1 K1_AD9
  s_cmp_eq_u32 s10, 0
  s_cbranch_scc1 K1_AD8
  s_mov_b64 exec, s[10:11]
  buffer_store_dwordx4 v[252:255], v167, s[28:31], s27 offen sc1
  s_add_u32 s16, s16, 1
  s_mov_b64 exec, -1
K1_AD8:
  s_cmp_lg_u32 s50, 9
  s_cbranch_scc1 K1_AD9
K1_AD1:
  buffer_load_dword v164, v165, s[56:59], 0 offen sc1
  s_mov_b32 s16, 0
  s_mov_b32 s50, 2
  s_setpc_b64 s[48:49]
K1_AD4:
  v_min3_u32 v144, v228, v229, v230
  v_min3_u32 v145, v231, v232, v233
  v_min3_u32 v144, v234, v235, v144
  v_min_u32 v144, v144, v145
  v_cmp_eq_u32 s[46:47], 0, v144
  s_mov_b32 s50, 3
  s_cmp_lg_u64 s[46:47], 0
  s_nop 2
  s_cbranch_scc1 K1_AD9
  buffer_load_dwordx4 v[156:159], v150, s[28:31], s32 offen sc1
  s_mov_b32 s50, 5
  s_mov_b32 s16, 0
  s_cmp_eq_u32 s87, 7
  s_cbranch_scc1 K1_AD7
  s_add_u32 s32, s32, 229376
  buffer_load_dwordx4 v[160:163], v150, s[28:31], s32 offen sc1
  s_setpc_b64 s[48:49]
K1_AD7:
  v_and_b32 v144, 1, v1
  v_lshlrev_b32 v144, 3, v144
  v_sub_u32 v144, v150, v144
  s_and_b32 s32, s62, -2
  s_lshl_b32 s32, s32, 3
  s_add_u32 s32, s32, 229376
  buffer_load_dwordx2 v[160:161], v144, s[28:31], s32 offen sc1
  buffer_load_dwordx2 v[162:163], v144, s[28:31], s32 offen offset:3584 sc1
  s_setpc_b64 s[48:49]
K1_AD3:
  s_mov_b64 exec, s[46:47]
  buffer_load_dwordx4 v[228:231], v166, s[28:31], s60 offen sc1
  buffer_load_dwordx4 v[232:235], v166, s[28:31], s60 offen offset:16 sc1
  s_mov_b64 exec, -1
  s_mov_b32 s50, 4
  s_mov_b32 s16, 0
K1_AD9:
  s_setpc_b64 s[48:49]
K1_MSLOW:
  s_movk_i32 s63, 3000
K1_MP:
  s_sleep 4
  buffer_load_dword v20, v251, s[28:31], s33 offen sc1
  s_waitcnt vmcnt(0)
  v_and_b32 v2, 1, v20
  v_cmp_ne_u32 vcc, 1, v2
  s_nop 4
  s_cbranch_vccz K1_MOK
  s_sub_u32 s63, s63, 1
  s_cbranch_scc0 K1_MP
  s_branch K1_MOK
K1_P2:
  s_setprio 0
  ds_read_b64_tr_b16 v[192:193], v241 offset:16384
  ds_read_b64_tr_b16 v[194:195], v241 offset:17408
  ds_read_b64_tr_b16 v[196:197], v241 offset:20480
  ds_read_b64_tr_b16 v[198:199], v241 offset:21504
  ds_read_b64_tr_b16 v[200:201], v241 offset:32768
  ds_read_b64_tr_b16 v[202:203], v241 offset:33792
  ds_read_b64_tr_b16 v[204:205], v241 offset:36864
  ds_read_b64_tr_b16 v[206:207], v241 offset:37888
  ds_read_b64_tr_b16 v[208:209], v242 offset:0
  ds_read_b64_tr_b16 v[210:211], v242 offset:1024
  ds_read_b64_tr_b16 v[212:213], v242 offset:4096
  ds_read_b64_tr_b16 v[214:215], v242 offset:5120
  v_mov_b32 v0, v243
  v_mov_b32 v24, v1
  s_mov_b32 s4, s87
  s_lshr_b32 s3, s2, 3
  s_and_b32 s5, s2, 3
  s_bfe_u32 s8, s2, 0x10002
  s_mul_i32 s9, s3, 37
  s_lshr_b32 s9, s9, 8
  s_lshl_b32 s5, s5, 2
  s_add_u32 s5, s5, s9
  s_mul_i32 s9, s9, 7
  s_sub_u32 s7, s3, s9
  s_mul_i32 s6, s8, 7
  s_add_u32 s6, s6, s7
  s_waitcnt lgkmcnt(0)
  s_barrier
  s_load_dwordx2 s[36:37], s[0:1], 96
  s_load_dwordx2 s[40:41], s[0:1], 120
  s_add_u32 m0, s86, 81920
  s_add_u32 s85, s88, 344064
  s_sub_u32 s47, s85, 688128
  s_min_u32 s85, s85, s47
  s_add_u32 s85, s85, s90
  buffer_load_dwordx4 v240, s[80:83], s85 offen lds
  s_movk_i32 s14, 4000
  v_lshrrev_b32 v27, 4, v24
  v_and_b32 v39, 1, v27
  v_lshlrev_b32 v22, 6, v39
  v_lshlrev_b32 v38, 4, v24
  v_xor_b32 v22, v22, v38
  s_mul_i32 s15, s5, 114688
  s_lshl_b32 s13, s4, 10
  s_add_u32 s15, s15, s13
  s_add_u32 s15, s15, 3670016
  v_add_u32 v22, s15, v22
  s_and_b32 s11, s2, 7
  s_mul_i32 s11, s11, 56
  s_add_u32 s11, s11, s4
  s_lshl_b32 s11, s11, 8
  s_add_u32 s11, s11, 12967936
  v_lshrrev_b32 v26, 3, v24
  v_and_b32 v25, 3, v24
  v_lshlrev_b32 v25, 6, v25
  v_med3_u32 v80, v26, 6, 6
  s_add_u32 s85, s85, 13312
  buffer_load_dwordx4 v240, s[80:83], s85 offen offset:1024 lds
  v_lshl_add_u32 v80, v80, 11, v25
  v_min_u32 v26, 5, v26
  v_lshl_add_u32 v25, v26, 11, v25
  v_mov_b32 v26, 1
  v_mov_b32 v81, 1
  v_lshlrev_b32 v112, 4, v0
  s_mov_b32 s38, 1605632
  s_mov_b32 s39, 0x00020000
  s_mov_b32 s42, 1835008
  s_mov_b32 s43, 0x00020000
  s_mov_b32 s23, 0xbfb8aa3b
  s_mov_b32 s24, 0xffff0000
  s_mov_b32 s25, 0x01000100
  s_mov_b32 s26, 0x03020302
  v_bfe_u32 v36, v0, 2, 2
  v_and_b32 v37, 3, v0
  v_lshlrev_b32 v37, 3, v37
  v_lshrrev_b32 v4, 5, v24
  v_lshl_add_u32 v4, v4, 3, v36
  v_lshlrev_b32 v4, 7, v4
  s_add_u32 m0, s86, 98304
  s_add_u32 s85, s88, 458752
  s_sub_u32 s47, s85, 688128
  s_min_u32 s85, s85, s47
  s_add_u32 s85, s85, s90
  buffer_load_dwordx4 v240, s[80:83], s85 offen lds
  v_lshl_add_u32 v4, v39, 5, v4
  v_and_b32 v38, 8, v0
  v_lshl_add_u32 v4, v38, 3, v4
  v_add_u32 v4, v4, v37
  v_xor_b32 v5, 64, v4
  v_lshrrev_b32 v1, 5, v24
  v_bfe_u32 v38, v0, 3, 2
  v_lshl_add_u32 v1, v1, 3, v38
  v_mul_u32_u24 v1, 896, v1
  v_and_b32 v38, 7, v0
  v_lshlrev_b32 v38, 4, v38
  v_lshlrev_b32 v39, 5, v27
  v_xor_b32 v38, v38, v39
  v_add_u32 v1, v1, v38
  s_mul_i32 s16, s4, 200704
  s_lshl_b32 s17, s7, 7
  s_add_u32 s16, s16, s17
  v_add_u32 v1, s16, v1
  s_and_b32 s12, s5, 3
  s_mul_i32 s12, s12, 0
  s_add_u32 s85, s85, 13312
  buffer_load_dwordx4 v240, s[80:83], s85 offen offset:1024 lds
  s_add_u32 s12, s12, s7
  s_sub_u32 s16, s12, 7
  s_min_u32 s12, s12, s16
  s_mul_i32 s12, s12, 0
  s_mul_i32 s16, s12, 28672
  s_mul_i32 s17, s4, 6144
  v_lshrrev_b32 v8, 2, v24
  v_lshlrev_b32 v8, 7, v8
  v_bfe_u32 v38, v0, 3, 2
  v_lshl_add_u32 v8, v38, 5, v8
  v_add3_u32 v8, v8, v37, s17
  v_xor_b32 v9, 32, v8
  v_xor_b32 v10, 64, v8
  v_xor_b32 v11, 96, v8
  v_and_b32 v2, 1, v27
  v_mul_u32_u24 v2, 57344, v2
  v_lshrrev_b32 v38, 5, v24
  v_lshl_add_u32 v2, v38, 8, v2
  v_and_b32 v38, 15, v0
  v_lshl_add_u32 v2, v38, 4, v2
  s_add_u32 m0, s86, 114688
  s_add_u32 s85, s88, 573440
  s_sub_u32 s47, s85, 688128
  s_min_u32 s85, s85, s47
  s_add_u32 s85, s85, s90
  buffer_load_dwordx4 v240, s[80:83], s85 offen lds
  s_lshl_b32 s19, s6, 3
  s_add_u32 s19, s19, s4
  s_mul_i32 s21, s5, 458752
  s_add_u32 s21, s21, 5505024
  s_lshl_b32 s18, s19, 9
  s_add_u32 s18, s18, s21
  s_mul_i32 s15, s8, 57344
  s_add_u32 s21, s21, s15
  s_mul_i32 s15, s4, 7168
  s_add_u32 s21, s21, s15
  s_lshl_b32 s22, s5, 9
  s_add_u32 s22, s22, 12918784
  v_and_b32 v21, 31, v0
  v_lshlrev_b32 v21, 2, v21
  v_bfe_u32 v38, v0, 4, 3
  v_xor_b32 v38, v38, v0
  v_bfe_u32 v23, v38, 2, 1
  v_mul_u32_u24 v23, 57344, v23
  v_lshrrev_b32 v39, 3, v24
  v_lshl_add_u32 v23, v39, 7, v23
  s_add_u32 s85, s85, 13312
  buffer_load_dwordx4 v240, s[80:83], s85 offen offset:1024 lds
  v_and_b32 v39, 2, v38
  v_lshl_add_u32 v23, v39, 5, v23
  v_and_b32 v39, 1, v38
  v_lshl_add_u32 v23, v39, 4, v23
  s_mul_i32 s44, s5, 114688
  s_lshl_b32 s15, s7, 13
  s_add_u32 s44, s44, s15
  s_add_u32 s44, s44, s13
  s_lshl_b32 s15, s8, 5
  s_add_u32 s44, s44, s15
  s_add_u32 s44, s44, 1835008
  s_lshl_b32 s27, s5, 3
  s_add_u32 s27, s27, s8
  s_mul_i32 s27, s27, 14336
  s_lshl_b32 s15, s7, 7
  s_add_u32 s27, s27, s15
  s_lshl_b32 s45, s7, 8
  s_add_u32 s45, s45, 12911360
  s_lshl_b32 s46, s19, 8
  s_add_u32 s46, s46, 12935168
  s_lshl_b32 s12, s12, 10
  s_add_u32 s19, s12, 1024
  s_sub_u32 s15, s19, 7168
  s_min_u32 s19, s19, s15
  s_add_u32 s20, s12, 2048
  s_sub_u32 s15, s20, 7168
  s_min_u32 s20, s20, s15
  s_add_u32 s32, s12, 3072
  s_sub_u32 s15, s32, 7168
  s_min_u32 s32, s32, s15
  s_add_u32 s33, s12, 4096
  s_sub_u32 s15, s33, 7168
  s_min_u32 s33, s33, s15
  s_add_u32 s34, s12, 5120
  s_sub_u32 s15, s34, 7168
  s_min_u32 s34, s34, s15
  s_add_u32 s35, s12, 6144
  s_sub_u32 s15, s35, 7168
  s_min_u32 s35, s35, s15
  s_waitcnt vmcnt(4)
  buffer_load_dword v26, v25, s[28:31], s11 offen sc1
  s_mov_b64 exec, 0
  s_branch K3C_H0
K3C_HE:
  s_mov_b64 exec, -1
  s_nop 0
  s_waitcnt vmcnt(0)
  v_cmp_eq_u32 vcc, 0, v26
  s_nop 1
  s_cbranch_vccnz K3_SLX
K3_OKX:
  s_add_u32 m0, s13, 0
  s_mov_b32 s15, 0
  buffer_load_dwordx4 v22, s[28:31], s15 offen sc1 lds
  s_add_u32 m0, s13, 8192
  s_mov_b32 s15, 8192
  buffer_load_dwordx4 v22, s[28:31], s15 offen sc1 lds
  v_mov_b32 v17, v241
  s_barrier
  ds_read_b64_tr_b16 v[216:217], v242 offset:32768
  ds_read_b64_tr_b16 v[218:219], v242 offset:33792
  ds_read_b64_tr_b16 v[220:221], v242 offset:36864
  ds_read_b64_tr_b16 v[222:223], v242 offset:37888
  ds_read_b64_tr_b16 v[224:225], v242 offset:16384
  ds_read_b64_tr_b16 v[226:227], v242 offset:17408
  ds_read_b64_tr_b16 v[228:229], v242 offset:20480
  ds_read_b64_tr_b16 v[230:231], v242 offset:21504
  ds_read_b64_tr_b16 v[232:233], v241 offset:0
  ds_read_b64_tr_b16 v[234:235], v241 offset:1024
  ds_read_b64_tr_b16 v[236:237], v241 offset:4096
  ds_read_b64_tr_b16 v[238:239], v241 offset:5120
  ds_read_b64_tr_b16 v[144:145], v241 offset:16384
  ds_read_b64_tr_b16 v[146:147], v241 offset:17408
  ds_read_b64_tr_b16 v[148:149], v241 offset:20480
  ds_read_b64_tr_b16 v[150:151], v241 offset:21504
  ds_read_b64_tr_b16 v[152:153], v241 offset:32768
  ds_read_b64_tr_b16 v[154:155], v241 offset:33792
  ds_read_b64_tr_b16 v[156:157], v241 offset:36864
  ds_read_b64_tr_b16 v[158:159], v241 offset:37888
  ds_read_b64_tr_b16 v[160:161], v242 offset:0
  ds_read_b64_tr_b16 v[162:163], v242 offset:1024
  ds_read_b64_tr_b16 v[164:165], v242 offset:4096
  ds_read_b64_tr_b16 v[166:167], v242 offset:5120
  s_add_u32 m0, s13, 16384
  s_mov_b32 s15, 16384
  buffer_load_dwordx4 v22, s[28:31], s15 offen sc1 lds
  s_add_u32 m0, s13, 24576
  s_add_u32 s15, s89, 0
  s_sub_u32 s47, s15, 24576
  s_min_u32 s15, s15, s47
  s_add_u32 s15, s15, 24576
  buffer_load_dwordx4 v22, s[28:31], s15 offen sc1 lds
  s_add_u32 m0, s13, 32768
  s_add_u32 s15, s89, 8192
  s_sub_u32 s47, s15, 24576
  s_min_u32 s15, s15, s47
  s_add_u32 s15, s15, 24576
  buffer_load_dwordx4 v22, s[28:31], s15 offen sc1 lds
  s_add_u32 m0, s13, 40960
  s_add_u32 s15, s89, 16384
  s_sub_u32 s47, s15, 24576
  s_min_u32 s15, s15, s47
  s_add_u32 s15, s15, 24576
  buffer_load_dwordx4 v22, s[28:31], s15 offen sc1 lds
  s_waitcnt vmcnt(4)
  ds_read_b128 v[116:119], v112 offset:0
  ds_read_b128 v[120:123], v112 offset:8192
  s_waitcnt lgkmcnt(0)
  v_max_u32 v116, v116, v118
  v_max3_u32 v116, v120, v122, v116
  v_cmp_eq_u32 vcc, -1, v116
  s_nop 1
  s_cbranch_vccnz K3_SLB00
K3_OKB00:
  s_barrier
  ds_read_b64_tr_b16 v[56:57], v4 offset:0
  ds_read_b64_tr_b16 v[58:59], v4 offset:512
  ds_read_b64_tr_b16 v[60:61], v4 offset:2048
  ds_read_b64_tr_b16 v[62:63], v4 offset:2560
  ds_read_b64_tr_b16 v[64:65], v4 offset:4096
  ds_read_b64_tr_b16 v[66:67], v4 offset:4608
  ds_read_b64_tr_b16 v[68:69], v4 offset:6144
  ds_read_b64_tr_b16 v[70:71], v4 offset:6656
  s_setprio 1
  s_waitcnt lgkmcnt(4)
  v_mfma_f32_32x32x16_bf16 v[24:39], v[168:171], v[56:59], 0
  ds_read_b64_tr_b16 v[72:73], v4 offset:8192
  ds_read_b64_tr_b16 v[74:75], v4 offset:8704
  buffer_load_dword v81, v80, s[28:31], s11 offen sc1
  s_waitcnt vmcnt(3)
  ds_read_b128 v[116:119], v112 offset:16384
  ds_read_b128 v[120:123], v112 offset:24576
  v_mfma_f32_32x32x16_bf16 v[24:39], v[172:175], v[60:63], v[24:39]
  ds_read_b64_tr_b16 v[76:77], v4 offset:10240
  ds_read_b64_tr_b16 v[78:79], v4 offset:10752
  s_add_u32 m0, s86, 65536
  s_add_u32 s85, s84, 1376256
  buffer_load_dwordx4 v240, s[80:83], s85 offen lds
  s_add_u32 s85, s85, 13312
  buffer_load_dwordx4 v240, s[80:83], s85 offen offset:1024 lds
  s_setprio 0
  s_waitcnt lgkmcnt(6)
  v_mfma_f32_32x32x16_bf16 v[24:39], v[176:179], v[64:67], v[24:39]
  ds_read_b64_tr_b16 v[56:57], v4 offset:12288
  ds_read_b64_tr_b16 v[58:59], v4 offset:12800
  v_lshlrev_b32 v15, 1, v21
  v_mfma_f32_32x32x16_bf16 v[24:39], v[180:183], v[68:71], v[24:39]
  ds_read_b64_tr_b16 v[60:61], v4 offset:14336
  ds_read_b64_tr_b16 v[62:63], v4 offset:14848
  s_add_u32 m0, s86, 81920
  s_add_u32 s85, s84, 1490944
  buffer_load_dwordx4 v240, s[80:83], s85 offen lds
  s_add_u32 s85, s85, 13312
  buffer_load_dwordx4 v240, s[80:83], s85 offen offset:1024 lds
  s_waitcnt lgkmcnt(6)
  v_max_u32 v116, v116, v118
  v_max3_u32 v116, v120, v122, v116
  v_cmp_eq_u32 vcc, -1, v116
  s_nop 1
  s_cbranch_vccnz K3_SLB02
K3_OKB02:
  s_barrier
  s_setprio 3
  s_waitcnt lgkmcnt(4)
K3C_H0:
  s_cbranch_execz K3C_H1
  s_nop 0
  v_mfma_f32_32x32x16_bf16 v[24:39], v[184:187], v[72:75], v[24:39]
  ds_read_b64_tr_b16 v[64:65], v4 offset:16384
  ds_read_b64_tr_b16 v[66:67], v4 offset:16896
  v_mfma_f32_32x32x16_bf16 v[24:39], v[188:191], v[76:79], v[24:39]
  ds_read_b64_tr_b16 v[68:69], v4 offset:18432
  ds_read_b64_tr_b16 v[70:71], v4 offset:18944
  s_setprio 2
  s_waitcnt lgkmcnt(4)
  v_mfma_f32_32x32x16_bf16 v[24:39], v[192:195], v[56:59], v[24:39]
  ds_read_b64_tr_b16 v[72:73], v4 offset:20480
  ds_read_b64_tr_b16 v[74:75], v4 offset:20992
  s_waitcnt vmcnt(4)
  v_cmp_eq_u32 vcc, 0, v81
  v_mfma_f32_32x32x16_bf16 v[24:39], v[196:199], v[60:63], v[24:39]
  ds_read_b64_tr_b16 v[76:77], v4 offset:22528
  ds_read_b64_tr_b16 v[78:79], v4 offset:23040
  s_cbranch_vccnz K3_SLY
K3_OKY:
  s_add_u32 m0, s13, 49152
  s_mov_b32 s15, 49152
  buffer_load_dwordx4 v22, s[28:31], s15 offen sc1 lds
  s_setprio 1
  s_waitcnt lgkmcnt(4)
  v_mfma_f32_32x32x16_bf16 v[24:39], v[200:203], v[64:67], v[24:39]
  ds_read_b64_tr_b16 v[56:57], v4 offset:24576
  ds_read_b64_tr_b16 v[58:59], v4 offset:25088
  ds_read_b128 v[116:119], v112 offset:32768
  ds_read_b128 v[120:123], v112 offset:40960
  v_mfma_f32_32x32x16_bf16 v[24:39], v[204:207], v[68:71], v[24:39]
  ds_read_b64_tr_b16 v[60:61], v4 offset:26624
  ds_read_b64_tr_b16 v[62:63], v4 offset:27136
  s_add_u32 m0, s13, 106496
  s_mov_b32 s15, 57344
  buffer_load_dwordx4 v22, s[28:31], s15 offen sc1 lds
  s_setprio 0
  s_waitcnt lgkmcnt(6)
  v_mfma_f32_32x32x16_bf16 v[24:39], v[208:211], v[72:75], v[24:39]
  ds_read_b64_tr_b16 v[64:65], v4 offset:28672
  ds_read_b64_tr_b16 v[66:67], v4 offset:29184
  v_mfma_f32_32x32x16_bf16 v[24:39], v[212:215], v[76:79], v[24:39]
  ds_read_b64_tr_b16 v[68:69], v4 offset:30720
  ds_read_b64_tr_b16 v[70:71], v4 offset:31232
  s_add_u32 m0, s13, 114688
  s_mov_b32 s15, 65536
  buffer_load_dwordx4 v22, s[28:31], s15 offen sc1 lds
  s_waitcnt lgkmcnt(6)
  v_max_u32 v116, v116, v118
  v_max3_u32 v116, v120, v122, v116
  v_cmp_eq_u32 vcc, -1, v116
  s_nop 1
  s_cbranch_vccnz K3_SLB04
K3_OKB04:
  s_barrier
  s_setprio 3
  s_waitcnt lgkmcnt(4)
  v_mfma_f32_32x32x16_bf16 v[24:39], v[216:219], v[56:59], v[24:39]
  ds_read_b64_tr_b16 v[72:73], v4 offset:32768
  ds_read_b64_tr_b16 v[74:75], v4 offset:33280
  v_mfma_f32_32x32x16_bf16 v[24:39], v[220:223], v[60:63], v[24:39]
  ds_read_b64_tr_b16 v[76:77], v4 offset:34816
  ds_read_b64_tr_b16 v[78:79], v4 offset:35328
  s_add_u32 m0, s13, 122880
  s_mov_b32 s15, 73728
  buffer_load_dwordx4 v22, s[28:31], s15 offen sc1 lds
  s_waitcnt vmcnt(4)
  s_barrier
  s_setprio 2
  s_waitcnt lgkmcnt(4)
  v_mfma_f32_32x32x16_bf16 v[24:39], v[224:227], v[64:67], v[24:39]
  ds_read_b64_tr_b16 v[56:57], v4 offset:36864
  ds_read_b64_tr_b16 v[58:59], v4 offset:37376
  ds_read_b64_tr_b16 v[240:241], v17 offset:0
  ds_read_b64_tr_b16 v[242:243], v17 offset:1024
  v_mfma_f32_32x32x16_bf16 v[24:39], v[228:231], v[68:71], v[24:39]
  ds_read_b64_tr_b16 v[60:61], v4 offset:38912
  ds_read_b64_tr_b16 v[62:63], v4 offset:39424
  ds_read_b64_tr_b16 v[244:245], v17 offset:4096
  ds_read_b64_tr_b16 v[246:247], v17 offset:5120
  s_add_u32 m0, s13, 131072
  s_add_u32 s15, s89, 0
  s_sub_u32 s47, s15, 24576
  s_min_u32 s15, s15, s47
  s_add_u32 s15, s15, 81920
  buffer_load_dwordx4 v22, s[28:31], s15 offen sc1 lds
  s_setprio 1
  s_waitcnt lgkmcnt(8)
  v_mfma_f32_32x32x16_bf16 v[24:39], v[232:235], v[72:75], v[24:39]
  ds_read_b64_tr_b16 v[64:65], v4 offset:40960
  ds_read_b64_tr_b16 v[66:67], v4 offset:41472
  ds_read_b64_tr_b16 v[248:249], v17 offset:16384
  ds_read_b64_tr_b16 v[250:251], v17 offset:17408
  v_mfma_f32_32x32x16_bf16 v[24:39], v[236:239], v[76:79], v[24:39]
  ds_read_b64_tr_b16 v[68:69], v4 offset:43008
  ds_read_b64_tr_b16 v[70:71], v4 offset:43520
  ds_read_b64_tr_b16 v[252:253], v17 offset:20480
  ds_read_b64_tr_b16 v[254:255], v17 offset:21504
  s_add_u32 m0, s13, 139264
  s_add_u32 s15, s89, 8192
  s_sub_u32 s47, s15, 24576
  s_min_u32 s15, s15, s47
  s_add_u32 s15, s15, 81920
  buffer_load_dwordx4 v22, s[28:31], s15 offen sc1 lds
  s_setprio 0
  s_waitcnt lgkmcnt(10)
  v_mfma_f32_32x32x16_bf16 v[24:39], v[144:147], v[56:59], v[24:39]
  ds_read_b64_tr_b16 v[72:73], v4 offset:45056
  ds_read_b64_tr_b16 v[74:75], v4 offset:45568
  s_waitcnt vmcnt(5)
  ds_read_b128 v[116:119], v112 offset:49152
  v_mfma_f32_32x32x16_bf16 v[24:39], v[148:151], v[60:63], v[24:39]
  ds_read_b64_tr_b16 v[76:77], v4 offset:47104
  ds_read_b64_tr_b16 v[78:79], v4 offset:47616
  s_add_u32 m0, s13, 147456
  s_add_u32 s15, s89, 16384
  s_sub_u32 s47, s15, 24576
  s_min_u32 s15, s15, s47
  s_add_u32 s15, s15, 81920
  buffer_load_dwordx4 v22, s[28:31], s15 offen sc1 lds
  s_waitcnt lgkmcnt(2)
  v_max_u32 v116, v116, v118
  v_cmp_eq_u32 vcc, -1, v116
  s_nop 1
  s_cbranch_vccnz K3_SLB06
K3_OKB06:
  s_barrier
  s_setprio 3
  v_mfma_f32_32x32x16_bf16 v[24:39], v[152:155], v[64:67], v[24:39]
  ds_read_b64_tr_b16 v[56:57], v4 offset:49152
  ds_read_b64_tr_b16 v[58:59], v4 offset:49664
  v_add_u32 v112, 106496, v112
  v_mfma_f32_32x32x16_bf16 v[24:39], v[156:159], v[68:71], v[24:39]
  ds_read_b64_tr_b16 v[60:61], v4 offset:51200
  ds_read_b64_tr_b16 v[62:63], v4 offset:51712
  s_add_u32 m0, s13, 155648
  s_mov_b32 s15, 106496
  buffer_load_dwordx4 v22, s[28:31], s15 offen sc1 lds
  s_setprio 2
  s_waitcnt lgkmcnt(4)
  v_mfma_f32_32x32x16_bf16 v[24:39], v[160:163], v[72:75], v[24:39]
  ds_read_b64_tr_b16 v[64:65], v4 offset:53248
  ds_read_b64_tr_b16 v[66:67], v4 offset:53760
  v_mov_b32 v14, 0
  v_mfma_f32_32x32x16_bf16 v[24:39], v[164:167], v[76:79], v[24:39]
  ds_read_b64_tr_b16 v[68:69], v4 offset:55296
  ds_read_b64_tr_b16 v[70:71], v4 offset:55808
  s_add_u32 m0, s17, 57344
  s_add_u32 s15, s16, 13312
  buffer_load_dwordx4 v1, s[36:39], s16 offen lds
  s_setprio 1
  s_waitcnt lgkmcnt(4)
  v_mfma_f32_32x32x16_bf16 v[24:39], v[240:243], v[56:59], v[24:39]
  ds_read_b64_tr_b16 v[72:73], v5 offset:0
  ds_read_b64_tr_b16 v[74:75], v5 offset:512
  buffer_load_dwordx4 v1, s[36:39], s15 offen offset:1024 lds
  s_add_u32 s16, s16, 3584
  v_mfma_f32_32x32x16_bf16 v[24:39], v[244:247], v[60:63], v[24:39]
  ds_read_b64_tr_b16 v[76:77], v5 offset:2048
  ds_read_b64_tr_b16 v[78:79], v5 offset:2560
  s_setprio 0
  s_waitcnt lgkmcnt(4)
  v_mfma_f32_32x32x16_bf16 v[24:39], v[248:251], v[64:67], v[24:39]
  ds_read_b64_tr_b16 v[56:57], v5 offset:4096
  ds_read_b64_tr_b16 v[58:59], v5 offset:4608
  s_waitcnt vmcnt(8)
  ds_read_b128 v[116:119], v112 offset:0
  buffer_load_dwordx2 v[12:13], v15, s[28:31], s46 offen sc1
  v_mfma_f32_32x32x16_bf16 v[24:39], v[252:255], v[68:71], v[24:39]
  ds_read_b64_tr_b16 v[60:61], v5 offset:6144
  ds_read_b64_tr_b16 v[62:63], v5 offset:6656
  v_add_u32 v4, 106496, v4
  s_add_u32 m0, s17, 59392
  s_add_u32 s15, s16, 13312
  buffer_load_dwordx4 v1, s[36:39], s16 offen lds
  s_setprio 3
  s_waitcnt lgkmcnt(5)
  v_mfma_f32_32x32x16_bf16 v[40:55], v[168:171], v[72:75], 0
  ds_read_b64_tr_b16 v[64:65], v5 offset:8192
  ds_read_b64_tr_b16 v[66:67], v5 offset:8704
  s_waitcnt vmcnt(9)
  ds_read_b128 v[120:123], v112 offset:8192
  buffer_load_dword v19, v21, s[28:31], s22 offen offset:0 sc1
  buffer_load_dwordx4 v1, s[36:39], s15 offen offset:1024 lds
  s_add_u32 s16, s16, 25088
  v_mfma_f32_32x32x16_bf16 v[40:55], v[172:175], v[76:79], v[40:55]
  ds_read_b64_tr_b16 v[68:69], v5 offset:10240
  ds_read_b64_tr_b16 v[70:71], v5 offset:10752
  s_setprio 2
  s_waitcnt lgkmcnt(5)
  v_mfma_f32_32x32x16_bf16 v[40:55], v[176:179], v[56:59], v[40:55]
  ds_read_b64_tr_b16 v[72:73], v5 offset:12288
  ds_read_b64_tr_b16 v[74:75], v5 offset:12800
  s_waitcnt vmcnt(10)
  ds_read_b128 v[124:127], v112 offset:16384
  buffer_load_dword v3, v21, s[28:31], s22 offen offset:128 sc1
  v_mfma_f32_32x32x16_bf16 v[40:55], v[180:183], v[60:63], v[40:55]
  ds_read_b64_tr_b16 v[76:77], v5 offset:14336
  ds_read_b64_tr_b16 v[78:79], v5 offset:14848
  v_max_u32 v116, v116, v118
  s_add_u32 m0, s17, 61440
  s_add_u32 s15, s16, 13312
  buffer_load_dwordx4 v1, s[36:39], s16 offen lds
  s_setprio 1
  s_waitcnt lgkmcnt(5)
  v_mfma_f32_32x32x16_bf16 v[40:55], v[184:187], v[64:67], v[40:55]
  ds_read_b64_tr_b16 v[56:57], v5 offset:16384
  ds_read_b64_tr_b16 v[58:59], v5 offset:16896
  s_waitcnt vmcnt(11)
  ds_read_b128 v[128:131], v112 offset:24576
  buffer_load_dwordx4 v1, s[36:39], s15 offen offset:1024 lds
  s_add_u32 s16, s16, 3584
  v_mfma_f32_32x32x16_bf16 v[40:55], v[188:191], v[68:71], v[40:55]
  ds_read_b64_tr_b16 v[60:61], v5 offset:18432
  ds_read_b64_tr_b16 v[62:63], v5 offset:18944
  v_max3_u32 v116, v120, v122, v116
  s_waitcnt vmcnt(7)
  ds_read_b64_tr_b16 v[80:81], v8 offset:57344
  ds_read_b64_tr_b16 v[84:85], v9 offset:57344
  s_setprio 0
  s_waitcnt lgkmcnt(7)
  v_mfma_f32_32x32x16_bf16 v[40:55], v[192:195], v[72:75], v[40:55]
  ds_read_b64_tr_b16 v[64:65], v5 offset:20480
  ds_read_b64_tr_b16 v[66:67], v5 offset:20992
  ds_read_b128 v[132:135], v112 offset:32768
  ds_read_b64_tr_b16 v[88:89], v10 offset:57344
  ds_read_b64_tr_b16 v[92:93], v11 offset:57344
  v_mfma_f32_32x32x16_bf16 v[40:55], v[196:199], v[76:79], v[40:55]
  ds_read_b64_tr_b16 v[68:69], v5 offset:22528
  ds_read_b64_tr_b16 v[70:71], v5 offset:23040
  v_max3_u32 v116, v124, v126, v116
  s_waitcnt lgkmcnt(2)
  s_add_u32 m0, s17, 57344
  s_add_u32 s15, s16, 13312
  buffer_load_dwordx4 v1, s[36:39], s16 offen lds
  s_setprio 3
  v_mfma_f32_32x32x16_bf16 v[40:55], v[200:203], v[56:59], v[40:55]
  ds_read_b64_tr_b16 v[72:73], v5 offset:24576
  ds_read_b64_tr_b16 v[74:75], v5 offset:25088
  ds_read_b128 v[136:139], v112 offset:40960
  s_waitcnt vmcnt(3)
  v_min3_u32 v20, v19, v3, v12
  v_cmp_eq_u32 vcc, 0, v20
  buffer_load_dwordx4 v1, s[36:39], s15 offen offset:1024 lds
  s_add_u32 s16, s16, 25088
  v_mfma_f32_32x32x16_bf16 v[40:55], v[204:207], v[60:63], v[40:55]
  ds_read_b64_tr_b16 v[76:77], v5 offset:26624
  ds_read_b64_tr_b16 v[78:79], v5 offset:27136
  v_max3_u32 v116, v128, v130, v116
  s_cbranch_vccnz K3_SLS
K3_OKS:
  s_mov_b32 exec_lo, 0
  v_mov_b32 v12, 0
  v_mov_b32 v13, 0
  s_mov_b32 exec_lo, -1
  v_mov_b32 v15, 0
  ds_read_b64_tr_b16 v[82:83], v8 offset:59392
  ds_read_b64_tr_b16 v[86:87], v9 offset:59392
  s_setprio 2
  s_waitcnt lgkmcnt(7)
  v_mfma_f32_32x32x16_bf16 v[40:55], v[208:211], v[64:67], v[40:55]
  ds_read_b64_tr_b16 v[56:57], v5 offset:28672
  ds_read_b64_tr_b16 v[58:59], v5 offset:29184
  ds_read_b128 v[140:143], v112 offset:49152
  v_and_b32 v18, s24, v19
  v_perm_b32 v16, v19, v19, s25
  v_rcp_f32 v20, v18
  ds_read_b64_tr_b16 v[90:91], v10 offset:59392
  ds_read_b64_tr_b16 v[94:95], v11 offset:59392
  v_mfma_f32_32x32x16_bf16 v[40:55], v[212:215], v[68:71], v[40:55]
  ds_read_b64_tr_b16 v[60:61], v5 offset:30720
  ds_read_b64_tr_b16 v[62:63], v5 offset:31232
  v_max3_u32 v116, v132, v134, v116
  v_perm_b32 v17, v19, v19, s26
  v_mul_f32 v20, s23, v20
  s_waitcnt lgkmcnt(2)
  s_add_u32 m0, s17, 59392
  s_add_u32 s15, s16, 13312
  buffer_load_dwordx4 v1, s[36:39], s16 offen lds
  v_mfma_f32_32x32x16_bf16 v[24:39], v[12:15], v[16:19], v[24:39]
  s_setprio 1
  v_mfma_f32_32x32x16_bf16 v[40:55], v[216:219], v[72:75], v[40:55]
  ds_read_b64_tr_b16 v[64:65], v5 offset:32768
  ds_read_b64_tr_b16 v[66:67], v5 offset:33280
  buffer_load_dwordx4 v1, s[36:39], s15 offen offset:1024 lds
  s_add_u32 s16, s16, 3584
  v_mfma_f32_32x32x16_bf16 v[40:55], v[220:223], v[76:79], v[40:55]
  ds_read_b64_tr_b16 v[68:69], v5 offset:34816
  ds_read_b64_tr_b16 v[70:71], v5 offset:35328
  v_max3_u32 v116, v136, v138, v116
  s_waitcnt vmcnt(4)
  ds_read_b64_tr_b16 v[96:97], v8 offset:61440
  ds_read_b64_tr_b16 v[100:101], v9 offset:61440
  s_setprio 0
  s_waitcnt lgkmcnt(6)
  v_mfma_f32_32x32x16_bf16 v[40:55], v[224:227], v[56:59], v[40:55]
  ds_read_b64_tr_b16 v[72:73], v5 offset:36864
  ds_read_b64_tr_b16 v[74:75], v5 offset:37376
  v_mul_f32 v24, v20, v24
  v_mul_f32 v25, v20, v25
  v_mul_f32 v26, v20, v26
  v_mul_f32 v27, v20, v27
  ds_read_b64_tr_b16 v[104:105], v10 offset:61440
  ds_read_b64_tr_b16 v[108:109], v11 offset:61440
  v_mfma_f32_32x32x16_bf16 v[40:55], v[228:231], v[60:63], v[40:55]
  ds_read_b64_tr_b16 v[76:77], v5 offset:38912
  ds_read_b64_tr_b16 v[78:79], v5 offset:39424
  v_max3_u32 v116, v140, v142, v116
  v_exp_f32 v24, v24
  v_mul_f32 v28, v20, v28
  v_exp_f32 v25, v25
  v_mul_f32 v29, v20, v29
  s_waitcnt lgkmcnt(2)
  s_add_u32 m0, s17, 61440
  s_add_u32 s15, s16, 13312
  buffer_load_dwordx4 v1, s[36:39], s16 offen lds
  s_setprio 3
  v_mfma_f32_32x32x16_bf16 v[40:55], v[232:235], v[64:67], v[40:55]
  ds_read_b64_tr_b16 v[56:57], v5 offset:40960
  ds_read_b64_tr_b16 v[58:59], v5 offset:41472
  v_cmp_eq_u32 vcc, -1, v116
  v_exp_f32 v26, v26
  v_mul_f32 v30, v20, v30
  v_exp_f32 v27, v27
  v_fma_f32 v24, v24, v18, v18
  buffer_load_dwordx4 v1, s[36:39], s15 offen offset:1024 lds
  s_add_u32 s16, s16, 25088
  v_mfma_f32_32x32x16_bf16 v[40:55], v[236:239], v[68:71], v[40:55]
  ds_read_b64_tr_b16 v[60:61], v5 offset:43008
  ds_read_b64_tr_b16 v[62:63], v5 offset:43520
  s_cbranch_vccnz K3_SLB10
K3_OKB10:
  v_mul_f32 v31, v20, v31
  v_exp_f32 v28, v28
  v_fma_f32 v25, v25, v18, v18
  v_exp_f32 v29, v29
  s_waitcnt vmcnt(4)
  ds_read_b64_tr_b16 v[98:99], v8 offset:57344
  ds_read_b64_tr_b16 v[102:103], v9 offset:57344
  s_setprio 2
  s_waitcnt lgkmcnt(6)
  v_mfma_f32_32x32x16_bf16 v[40:55], v[144:147], v[72:75], v[40:55]
  ds_read_b64_tr_b16 v[64:65], v5 offset:45056
  ds_read_b64_tr_b16 v[66:67], v5 offset:45568
  v_fma_f32 v26, v26, v18, v18
  v_exp_f32 v30, v30
  v_fma_f32 v27, v27, v18, v18
  v_rcp_f32 v24, v24
  ds_read_b64_tr_b16 v[106:107], v10 offset:57344
  ds_read_b64_tr_b16 v[110:111], v11 offset:57344
  v_mfma_f32_32x32x16_bf16 v[40:55], v[148:151], v[76:79], v[40:55]
  ds_read_b64_tr_b16 v[68:69], v5 offset:47104
  ds_read_b64_tr_b16 v[70:71], v5 offset:47616
  v_exp_f32 v31, v31
  v_fma_f32 v28, v28, v18, v18
  v_rcp_f32 v25, v25
  v_fma_f32 v29, v29, v18, v18
  s_waitcnt lgkmcnt(2)
  s_add_u32 m0, s17, 57344
  s_add_u32 s15, s16, 13312
  buffer_load_dwordx4 v1, s[36:39], s16 offen lds
  s_setprio 1
  v_mfma_f32_32x32x16_bf16 v[40:55], v[152:155], v[56:59], v[40:55]
  ds_read_b64_tr_b16 v[72:73], v5 offset:49152
  ds_read_b64_tr_b16 v[74:75], v5 offset:49664
  v_rcp_f32 v26, v26
  v_fma_f32 v30, v30, v18, v18
  v_rcp_f32 v27, v27
  v_mul_f32 v24, v24, v32
  buffer_load_dwordx4 v1, s[36:39], s15 offen offset:1024 lds
  s_add_u32 s16, s16, 3584
  v_mfma_f32_32x32x16_bf16 v[40:55], v[156:159], v[60:63], v[40:55]
  ds_read_b64_tr_b16 v[76:77], v5 offset:51200
  ds_read_b64_tr_b16 v[78:79], v5 offset:51712
  v_fma_f32 v31, v31, v18, v18
  v_rcp_f32 v28, v28
  v_mul_f32 v25, v25, v33
  v_rcp_f32 v29, v29
  s_waitcnt vmcnt(4)
  ds_read_b64_tr_b16 v[112:113], v8 offset:59392
  ds_read_b64_tr_b16 v[116:117], v9 offset:59392
  s_setprio 0
  s_waitcnt lgkmcnt(6)
  v_mfma_f32_32x32x16_bf16 v[40:55], v[160:163], v[64:67], v[40:55]
  ds_read_b64_tr_b16 v[56:57], v5 offset:53248
  ds_read_b64_tr_b16 v[58:59], v5 offset:53760
  v_mul_f32 v26, v26, v34
  v_rcp_f32 v30, v30
  v_mul_f32 v27, v27, v35
  v_rcp_f32 v31, v31
  ds_read_b64_tr_b16 v[120:121], v10 offset:59392
  ds_read_b64_tr_b16 v[124:125], v11 offset:59392
  v_mfma_f32_32x32x16_bf16 v[40:55], v[164:167], v[68:71], v[40:55]
  ds_read_b64_tr_b16 v[60:61], v5 offset:55296
  ds_read_b64_tr_b16 v[62:63], v5 offset:55808
  v_mul_f32 v28, v28, v36
  v_mul_f32 v29, v29, v37
  v_mul_f32 v30, v30, v38
  v_mul_f32 v31, v31, v39
  s_waitcnt lgkmcnt(2)
  s_add_u32 m0, s17, 59392
  s_add_u32 s15, s16, 13312
  buffer_load_dwordx4 v1, s[36:39], s16 offen lds
  s_barrier
  s_setprio 3
  v_mfma_f32_32x32x16_bf16 v[40:55], v[240:243], v[72:75], v[40:55]
  ds_read_b64_tr_b16 v[64:65], v4 offset:0
  ds_read_b64_tr_b16 v[66:67], v4 offset:512
  v_cvt_pk_bf16_f32 v32, v24, v25
  v_cvt_pk_bf16_f32 v33, v26, v27
  v_cvt_pk_bf16_f32 v34, v28, v29
  v_cvt_pk_bf16_f32 v35, v30, v31
  v_and_b32 v18, s24, v3
  buffer_load_dwordx4 v1, s[36:39], s15 offen offset:1024 lds
  s_add_u32 s16, s16, 25088
  v_mfma_f32_32x32x16_bf16 v[40:55], v[244:247], v[76:79], v[40:55]
  ds_read_b64_tr_b16 v[68:69], v4 offset:2048
  ds_read_b64_tr_b16 v[70:71], v4 offset:2560
  v_perm_b32 v16, v3, v3, s25
  v_rcp_f32 v20, v18
  s_waitcnt vmcnt(4)
  ds_read_b64_tr_b16 v[114:115], v8 offset:61440
  ds_read_b64_tr_b16 v[118:119], v9 offset:61440
  s_setprio 2
  s_waitcnt lgkmcnt(6)
  v_mfma_f32_32x32x16_bf16 v[40:55], v[248:251], v[56:59], v[40:55]
  ds_read_b64_tr_b16 v[72:73], v4 offset:4096
  ds_read_b64_tr_b16 v[74:75], v4 offset:4608
  v_perm_b32 v17, v3, v3, s26
  ds_read_b64_tr_b16 v[122:123], v10 offset:61440
  ds_read_b64_tr_b16 v[126:127], v11 offset:61440
  v_mfma_f32_32x32x16_bf16 v[40:55], v[252:255], v[60:63], v[40:55]
  ds_read_b64_tr_b16 v[76:77], v4 offset:6144
  ds_read_b64_tr_b16 v[78:79], v4 offset:6656
  v_add_u32 v5, 106496, v5
  buffer_store_dwordx4 v[32:35], v2, s[28:31], s18 offen sc1
  s_add_u32 s18, s18, 114688
  v_mul_f32 v20, s23, v20
  s_waitcnt lgkmcnt(2)
  s_add_u32 m0, s17, 61440
  s_add_u32 s15, s16, 13312
  buffer_load_dwordx4 v1, s[36:39], s16 offen lds
  v_mfma_f32_32x32x16_bf16 v[40:55], v[12:15], v[16:19], v[40:55]
  s_setprio 1
  v_mfma_f32_32x32x16_bf16 v[24:39], v[168:171], v[64:67], 0
  ds_read_b64_tr_b16 v[56:57], v4 offset:8192
  ds_read_b64_tr_b16 v[58:59], v4 offset:8704
  buffer_load_dwordx4 v1, s[36:39], s15 offen offset:1024 lds
  s_add_u32 s16, s16, 3584
  v_mfma_f32_32x32x16_bf16 v[24:39], v[172:175], v[68:71], v[24:39]
  ds_read_b64_tr_b16 v[60:61], v4 offset:10240
  ds_read_b64_tr_b16 v[62:63], v4 offset:10752
  buffer_load_dword v6, v21, s[28:31], s22 offen offset:256 sc1
  s_waitcnt vmcnt(6)
  ds_read_b64_tr_b16 v[128:129], v8 offset:57344
  ds_read_b64_tr_b16 v[132:133], v9 offset:57344
  s_setprio 0
  s_waitcnt lgkmcnt(6)
  v_mfma_f32_32x32x16_bf16 v[24:39], v[176:179], v[72:75], v[24:39]
  ds_read_b64_tr_b16 v[64:65], v4 offset:12288
  ds_read_b64_tr_b16 v[66:67], v4 offset:12800
  v_mul_f32 v40, v20, v40
  v_mul_f32 v41, v20, v41
  ds_read_b64_tr_b16 v[136:137], v10 offset:57344
  ds_read_b64_tr_b16 v[140:141], v11 offset:57344
  v_mfma_f32_32x32x16_bf16 v[24:39], v[180:183], v[76:79], v[24:39]
  ds_read_b64_tr_b16 v[68:69], v4 offset:14336
  ds_read_b64_tr_b16 v[70:71], v4 offset:14848
  buffer_load_dword v7, v21, s[28:31], s22 offen offset:384 sc1
  v_mul_f32 v42, v20, v42
  v_mul_f32 v43, v20, v43
  s_waitcnt lgkmcnt(2)
  s_add_u32 m0, s17, 57344
  s_add_u32 s15, s16, 13312
  buffer_load_dwordx4 v1, s[36:39], s16 offen lds
  s_setprio 3
  v_mfma_f32_32x32x16_bf16 v[24:39], v[184:187], v[56:59], v[24:39]
  ds_read_b64_tr_b16 v[72:73], v4 offset:16384
  ds_read_b64_tr_b16 v[74:75], v4 offset:16896
  v_exp_f32 v40, v40
  v_mul_f32 v44, v20, v44
  buffer_load_dwordx4 v1, s[36:39], s15 offen offset:1024 lds
  s_add_u32 s16, s16, 25088
  v_mfma_f32_32x32x16_bf16 v[24:39], v[188:191], v[60:63], v[24:39]
  ds_read_b64_tr_b16 v[76:77], v4 offset:18432
  ds_read_b64_tr_b16 v[78:79], v4 offset:18944
  v_exp_f32 v41, v41
  v_mul_f32 v45, v20, v45
  s_waitcnt vmcnt(7)
  ds_read_b64_tr_b16 v[130:131], v8 offset:59392
  ds_read_b64_tr_b16 v[134:135], v9 offset:59392
  s_setprio 2
  s_waitcnt lgkmcnt(6)
  v_mfma_f32_32x32x16_bf16 v[24:39], v[192:195], v[64:67], v[24:39]
  ds_read_b64_tr_b16 v[56:57], v4 offset:20480
  ds_read_b64_tr_b16 v[58:59], v4 offset:20992
  v_exp_f32 v42, v42
  v_mul_f32 v46, v20, v46
  ds_read_b64_tr_b16 v[138:139], v10 offset:59392
  ds_read_b64_tr_b16 v[142:143], v11 offset:59392
  v_mfma_f32_32x32x16_bf16 v[24:39], v[196:199], v[68:71], v[24:39]
  ds_read_b64_tr_b16 v[60:61], v4 offset:22528
  ds_read_b64_tr_b16 v[62:63], v4 offset:23040
  v_exp_f32 v43, v43
  v_fma_f32 v40, v40, v18, v18
  s_waitcnt lgkmcnt(2)
  s_add_u32 m0, s17, 59392
  s_add_u32 s15, s16, 13312
  buffer_load_dwordx4 v1, s[36:39], s16 offen lds
  s_setprio 1
  v_mfma_f32_32x32x16_bf16 v[24:39], v[200:203], v[72:75], v[24:39]
  ds_read_b64_tr_b16 v[64:65], v4 offset:24576
  ds_read_b64_tr_b16 v[66:67], v4 offset:25088
  v_mul_f32 v47, v20, v47
  v_exp_f32 v44, v44
  buffer_load_dwordx4 v1, s[36:39], s15 offen offset:1024 lds
  s_add_u32 s16, s16, 3584
  v_mfma_f32_32x32x16_bf16 v[24:39], v[204:207], v[76:79], v[24:39]
  ds_read_b64_tr_b16 v[68:69], v4 offset:26624
  ds_read_b64_tr_b16 v[70:71], v4 offset:27136
  v_fma_f32 v41, v41, v18, v18
  v_exp_f32 v45, v45
  s_setprio 0
  s_waitcnt lgkmcnt(4)
  v_mfma_f32_32x32x16_bf16 v[24:39], v[208:211], v[56:59], v[24:39]
  ds_read_b64_tr_b16 v[72:73], v4 offset:28672
  ds_read_b64_tr_b16 v[74:75], v4 offset:29184
  v_fma_f32 v42, v42, v18, v18
  v_exp_f32 v46, v46
  v_mfma_f32_32x32x16_bf16 v[24:39], v[212:215], v[60:63], v[24:39]
  ds_read_b64_tr_b16 v[76:77], v4 offset:30720
  ds_read_b64_tr_b16 v[78:79], v4 offset:31232
  v_fma_f32 v43, v43, v18, v18
  v_rcp_f32 v40, v40
  s_add_u32 m0, s17, 4096
  s_add_u32 s15, s16, 13312
  buffer_load_dwordx4 v1, s[36:39], s16 offen lds
  s_setprio 3
  s_waitcnt lgkmcnt(4)
  v_mfma_f32_32x32x16_bf16 v[24:39], v[216:219], v[64:67], v[24:39]
  ds_read_b64_tr_b16 v[56:57], v4 offset:32768
  ds_read_b64_tr_b16 v[58:59], v4 offset:33280
  v_exp_f32 v47, v47
  v_fma_f32 v44, v44, v18, v18
  buffer_load_dwordx4 v1, s[36:39], s15 offen offset:1024 lds
  s_add_u32 s16, s16, 25088
  v_mfma_f32_32x32x16_bf16 v[24:39], v[220:223], v[68:71], v[24:39]
  ds_read_b64_tr_b16 v[60:61], v4 offset:34816
  ds_read_b64_tr_b16 v[62:63], v4 offset:35328
  v_rcp_f32 v41, v41
  v_fma_f32 v45, v45, v18, v18
  s_setprio 2
  s_waitcnt lgkmcnt(4)
  v_mfma_f32_32x32x16_bf16 v[24:39], v[224:227], v[72:75], v[24:39]
  ds_read_b64_tr_b16 v[64:65], v4 offset:36864
  ds_read_b64_tr_b16 v[66:67], v4 offset:37376
  v_rcp_f32 v42, v42
  v_fma_f32 v46, v46, v18, v18
  v_mfma_f32_32x32x16_bf16 v[24:39], v[228:231], v[76:79], v[24:39]
  ds_read_b64_tr_b16 v[68:69], v4 offset:38912
  ds_read_b64_tr_b16 v[70:71], v4 offset:39424
  v_rcp_f32 v43, v43
  v_mul_f32 v40, v40, v48
  s_add_u32 m0, s17, 0
  s_add_u32 s15, s16, 13312
  buffer_load_dwordx4 v1, s[36:39], s16 offen lds
  s_setprio 1
  s_waitcnt lgkmcnt(4)
  v_mfma_f32_32x32x16_bf16 v[24:39], v[232:235], v[56:59], v[24:39]
  ds_read_b64_tr_b16 v[72:73], v4 offset:40960
  ds_read_b64_tr_b16 v[74:75], v4 offset:41472
  s_waitcnt vmcnt(7)
  v_min_u32 v22, v6, v7
  v_cmp_eq_u32 vcc, 0, v22
  v_fma_f32 v47, v47, v18, v18
  v_rcp_f32 v44, v44
  buffer_load_dwordx4 v1, s[36:39], s15 offen offset:1024 lds
  s_add_u32 s16, s16, 3584
  v_mfma_f32_32x32x16_bf16 v[24:39], v[236:239], v[60:63], v[24:39]
  ds_read_b64_tr_b16 v[76:77], v4 offset:43008
  ds_read_b64_tr_b16 v[78:79], v4 offset:43520
  s_cbranch_vccnz K3_SLS2
K3_OKS2:
  v_mul_f32 v41, v41, v49
  v_rcp_f32 v45, v45
  s_setprio 0
  s_waitcnt lgkmcnt(4)
  v_mfma_f32_32x32x16_bf16 v[24:39], v[144:147], v[64:67], v[24:39]
  ds_read_b64_tr_b16 v[56:57], v4 offset:45056
  ds_read_b64_tr_b16 v[58:59], v4 offset:45568
  v_and_b32 v21, 1, v0
  s_lshl_b32 s22, s5, 8
  v_mul_f32 v42, v42, v50
  v_rcp_f32 v46, v46
  v_mfma_f32_32x32x16_bf16 v[24:39], v[148:151], v[68:71], v[24:39]
  ds_read_b64_tr_b16 v[60:61], v4 offset:47104
  ds_read_b64_tr_b16 v[62:63], v4 offset:47616
  v_lshlrev_b32 v21, 7, v21
  s_add_u32 s22, s22, 12931072
  v_mul_f32 v43, v43, v51
  v_rcp_f32 v47, v47
  s_add_u32 m0, s17, 2048
  s_add_u32 s15, s16, 13312
  buffer_load_dwordx4 v1, s[36:39], s16 offen lds
  s_setprio 3
  s_waitcnt lgkmcnt(4)
  v_mfma_f32_32x32x16_bf16 v[24:39], v[152:155], v[72:75], v[24:39]
  ds_read_b64_tr_b16 v[64:65], v4 offset:49152
  ds_read_b64_tr_b16 v[66:67], v4 offset:49664
  v_mov_b32 v22, 1
  v_mul_f32 v44, v44, v52
  v_mul_f32 v45, v45, v53
  buffer_load_dwordx4 v1, s[36:39], s15 offen offset:1024 lds
  s_add_u32 s16, s16, 25088
  v_mfma_f32_32x32x16_bf16 v[24:39], v[156:159], v[76:79], v[24:39]
  ds_read_b64_tr_b16 v[68:69], v4 offset:51200
K3C_H1:
  s_cbranch_execz K3C_H2
  s_nop 0
  ds_read_b64_tr_b16 v[70:71], v4 offset:51712
  v_mul_f32 v46, v46, v54
  v_mul_f32 v47, v47, v55
  s_setprio 2
  s_waitcnt lgkmcnt(4)
  v_mfma_f32_32x32x16_bf16 v[24:39], v[160:163], v[56:59], v[24:39]
  ds_read_b64_tr_b16 v[72:73], v4 offset:53248
  ds_read_b64_tr_b16 v[74:75], v4 offset:53760
  v_cvt_pk_bf16_f32 v48, v40, v41
  v_cvt_pk_bf16_f32 v49, v42, v43
  v_mfma_f32_32x32x16_bf16 v[24:39], v[164:167], v[60:63], v[24:39]
  ds_read_b64_tr_b16 v[76:77], v4 offset:55296
  ds_read_b64_tr_b16 v[78:79], v4 offset:55808
  v_cvt_pk_bf16_f32 v50, v44, v45
  v_cvt_pk_bf16_f32 v51, v46, v47
  s_add_u32 m0, s13, 49152
  s_nop 0
  buffer_load_dwordx4 v23, s[28:31], s44 offen sc1 lds
  s_setprio 1
  s_waitcnt lgkmcnt(4)
  v_mfma_f32_32x32x16_bf16 v[24:39], v[240:243], v[64:67], v[24:39]
  ds_read_b64_tr_b16 v[56:57], v5 offset:0
  ds_read_b64_tr_b16 v[58:59], v5 offset:512
  v_and_b32 v18, s24, v6
  v_mfma_f32_32x32x16_bf16 v[24:39], v[244:247], v[68:71], v[24:39]
  ds_read_b64_tr_b16 v[60:61], v5 offset:2048
  ds_read_b64_tr_b16 v[62:63], v5 offset:2560
  v_perm_b32 v16, v6, v6, s25
  v_rcp_f32 v20, v18
  s_setprio 0
  s_waitcnt lgkmcnt(4)
  v_mfma_f32_32x32x16_bf16 v[24:39], v[248:251], v[72:75], v[24:39]
  ds_read_b64_tr_b16 v[64:65], v5 offset:4096
  ds_read_b64_tr_b16 v[66:67], v5 offset:4608
  v_perm_b32 v17, v6, v6, s26
  v_mfma_f32_32x32x16_bf16 v[24:39], v[252:255], v[76:79], v[24:39]
  ds_read_b64_tr_b16 v[68:69], v5 offset:6144
  ds_read_b64_tr_b16 v[70:71], v5 offset:6656
  buffer_store_dwordx4 v[48:51], v2, s[28:31], s18 offen sc1
  s_add_u32 s18, s18, 114688
  v_mul_f32 v20, s23, v20
  v_mfma_f32_32x32x16_bf16 v[24:39], v[12:15], v[16:19], v[24:39]
  s_setprio 3
  s_waitcnt lgkmcnt(4)
  v_mfma_f32_32x32x16_bf16 v[40:55], v[168:171], v[56:59], 0
  ds_read_b64_tr_b16 v[72:73], v5 offset:8192
  ds_read_b64_tr_b16 v[74:75], v5 offset:8704
  v_and_b32 v1, 63, v0
  v_mfma_f32_32x32x16_bf16 v[40:55], v[172:175], v[60:63], v[40:55]
  ds_read_b64_tr_b16 v[76:77], v5 offset:10240
  ds_read_b64_tr_b16 v[78:79], v5 offset:10752
  v_lshl_add_u32 v1, v1, 4, s21
  s_setprio 2
  s_waitcnt lgkmcnt(4)
  v_mfma_f32_32x32x16_bf16 v[40:55], v[176:179], v[64:67], v[40:55]
  ds_read_b64_tr_b16 v[56:57], v5 offset:12288
  ds_read_b64_tr_b16 v[58:59], v5 offset:12800
  v_mul_f32 v24, v20, v24
  v_mul_f32 v25, v20, v25
  v_mul_f32 v26, v20, v26
  buffer_load_dwordx4 v[168:171], v1, s[28:31], s12 offen sc1
  v_mfma_f32_32x32x16_bf16 v[40:55], v[180:183], v[68:71], v[40:55]
  ds_read_b64_tr_b16 v[60:61], v5 offset:14336
  ds_read_b64_tr_b16 v[62:63], v5 offset:14848
  v_mul_f32 v27, v20, v27
  v_exp_f32 v24, v24
  v_mul_f32 v28, v20, v28
  s_setprio 1
  s_waitcnt lgkmcnt(4)
  v_mfma_f32_32x32x16_bf16 v[40:55], v[184:187], v[72:75], v[40:55]
  ds_read_b64_tr_b16 v[64:65], v5 offset:16384
  ds_read_b64_tr_b16 v[66:67], v5 offset:16896
  v_exp_f32 v25, v25
  v_mul_f32 v29, v20, v29
  v_exp_f32 v26, v26
  buffer_load_dwordx4 v[172:175], v1, s[28:31], s19 offen sc1
  v_mfma_f32_32x32x16_bf16 v[40:55], v[188:191], v[76:79], v[40:55]
  ds_read_b64_tr_b16 v[68:69], v5 offset:18432
  ds_read_b64_tr_b16 v[70:71], v5 offset:18944
  buffer_load_dword v22, v21, s[28:31], s22 offen sc1
  v_mul_f32 v30, v20, v30
  v_exp_f32 v27, v27
  v_fma_f32 v24, v24, v18, v18
  s_setprio 0
  s_waitcnt lgkmcnt(4)
  v_mfma_f32_32x32x16_bf16 v[40:55], v[192:195], v[56:59], v[40:55]
  ds_read_b64_tr_b16 v[72:73], v5 offset:20480
  ds_read_b64_tr_b16 v[74:75], v5 offset:20992
  v_mul_f32 v31, v20, v31
  v_exp_f32 v28, v28
  v_fma_f32 v25, v25, v18, v18
  buffer_load_dwordx4 v[176:179], v1, s[28:31], s20 offen sc1
  v_mfma_f32_32x32x16_bf16 v[40:55], v[196:199], v[60:63], v[40:55]
  ds_read_b64_tr_b16 v[76:77], v5 offset:22528
  ds_read_b64_tr_b16 v[78:79], v5 offset:23040
  v_exp_f32 v29, v29
  v_fma_f32 v26, v26, v18, v18
  v_exp_f32 v30, v30
  s_setprio 3
  s_waitcnt lgkmcnt(4)
  v_mfma_f32_32x32x16_bf16 v[40:55], v[200:203], v[64:67], v[40:55]
  ds_read_b64_tr_b16 v[56:57], v5 offset:24576
  ds_read_b64_tr_b16 v[58:59], v5 offset:25088
  v_fma_f32 v27, v27, v18, v18
  v_rcp_f32 v24, v24
  v_exp_f32 v31, v31
  buffer_load_dwordx4 v[180:183], v1, s[28:31], s32 offen sc1
  v_mfma_f32_32x32x16_bf16 v[40:55], v[204:207], v[68:71], v[40:55]
  ds_read_b64_tr_b16 v[60:61], v5 offset:26624
  ds_read_b64_tr_b16 v[62:63], v5 offset:27136
  v_fma_f32 v28, v28, v18, v18
  v_rcp_f32 v25, v25
  v_fma_f32 v29, v29, v18, v18
  s_setprio 2
  s_waitcnt lgkmcnt(4)
  v_mfma_f32_32x32x16_bf16 v[40:55], v[208:211], v[72:75], v[40:55]
  ds_read_b64_tr_b16 v[64:65], v5 offset:28672
  ds_read_b64_tr_b16 v[66:67], v5 offset:29184
  v_rcp_f32 v26, v26
  v_fma_f32 v30, v30, v18, v18
  v_rcp_f32 v27, v27
  buffer_load_dwordx4 v[184:187], v1, s[28:31], s33 offen sc1
  v_mfma_f32_32x32x16_bf16 v[40:55], v[212:215], v[76:79], v[40:55]
  ds_read_b64_tr_b16 v[68:69], v5 offset:30720
  ds_read_b64_tr_b16 v[70:71], v5 offset:31232
  v_mul_f32 v24, v24, v32
  v_fma_f32 v31, v31, v18, v18
  v_rcp_f32 v28, v28
  s_setprio 1
  s_waitcnt lgkmcnt(4)
  v_mfma_f32_32x32x16_bf16 v[40:55], v[216:219], v[56:59], v[40:55]
  ds_read_b64_tr_b16 v[72:73], v5 offset:32768
  ds_read_b64_tr_b16 v[74:75], v5 offset:33280
  v_mul_f32 v25, v25, v33
  v_rcp_f32 v29, v29
  v_mul_f32 v26, v26, v34
  buffer_load_dwordx4 v[188:191], v1, s[28:31], s34 offen sc1
  v_mfma_f32_32x32x16_bf16 v[40:55], v[220:223], v[60:63], v[40:55]
  ds_read_b64_tr_b16 v[76:77], v5 offset:34816
  ds_read_b64_tr_b16 v[78:79], v5 offset:35328
  v_rcp_f32 v30, v30
  v_mul_f32 v27, v27, v35
  v_rcp_f32 v31, v31
  s_setprio 0
  s_waitcnt lgkmcnt(4)
  v_mfma_f32_32x32x16_bf16 v[40:55], v[224:227], v[64:67], v[40:55]
  ds_read_b64_tr_b16 v[56:57], v5 offset:36864
  ds_read_b64_tr_b16 v[58:59], v5 offset:37376
  v_mul_f32 v28, v28, v36
  v_mul_f32 v29, v29, v37
  v_mul_f32 v30, v30, v38
  buffer_load_dwordx4 v[192:195], v1, s[28:31], s35 offen sc1
  v_mfma_f32_32x32x16_bf16 v[40:55], v[228:231], v[68:71], v[40:55]
  ds_read_b64_tr_b16 v[60:61], v5 offset:38912
  ds_read_b64_tr_b16 v[62:63], v5 offset:39424
  v_mul_f32 v31, v31, v39
  v_cvt_pk_bf16_f32 v32, v24, v25
  v_cvt_pk_bf16_f32 v33, v26, v27
  s_setprio 3
  s_waitcnt lgkmcnt(4)
  v_mfma_f32_32x32x16_bf16 v[40:55], v[232:235], v[72:75], v[40:55]
  ds_read_b64_tr_b16 v[64:65], v5 offset:40960
  ds_read_b64_tr_b16 v[66:67], v5 offset:41472
  s_waitcnt vmcnt(5)
  v_cmp_eq_u32 vcc, 0, v22
  v_cvt_pk_bf16_f32 v34, v28, v29
  v_cvt_pk_bf16_f32 v35, v30, v31
  v_add_u32 v1, 114688, v1
  buffer_load_dwordx4 v[196:199], v1, s[28:31], s12 offen sc1
  v_mfma_f32_32x32x16_bf16 v[40:55], v[236:239], v[76:79], v[40:55]
  ds_read_b64_tr_b16 v[68:69], v5 offset:43008
  ds_read_b64_tr_b16 v[70:71], v5 offset:43520
  s_cbranch_vccnz K3_SLF
K3_OKF:
  s_setprio 2
  s_waitcnt lgkmcnt(4)
  v_mfma_f32_32x32x16_bf16 v[40:55], v[144:147], v[56:59], v[40:55]
  ds_read_b64_tr_b16 v[72:73], v5 offset:45056
  ds_read_b64_tr_b16 v[74:75], v5 offset:45568
  buffer_load_dwordx4 v[200:203], v1, s[28:31], s19 offen sc1
  v_mfma_f32_32x32x16_bf16 v[40:55], v[148:151], v[60:63], v[40:55]
  ds_read_b64_tr_b16 v[76:77], v5 offset:47104
  ds_read_b64_tr_b16 v[78:79], v5 offset:47616
  buffer_store_dwordx4 v[32:35], v2, s[28:31], s18 offen sc1
  s_add_u32 s18, s18, 114688
  s_setprio 1
  s_waitcnt lgkmcnt(4)
  v_mfma_f32_32x32x16_bf16 v[40:55], v[152:155], v[64:67], v[40:55]
  ds_read_b64_tr_b16 v[56:57], v5 offset:49152
  ds_read_b64_tr_b16 v[58:59], v5 offset:49664
  ds_read_b64_tr_b16 v[232:233], v8 offset:61440
  ds_read_b64_tr_b16 v[236:237], v9 offset:61440
  buffer_load_dwordx4 v[204:207], v1, s[28:31], s20 offen sc1
  v_mfma_f32_32x32x16_bf16 v[40:55], v[156:159], v[68:71], v[40:55]
  ds_read_b64_tr_b16 v[60:61], v5 offset:51200
  ds_read_b64_tr_b16 v[62:63], v5 offset:51712
  ds_read_b64_tr_b16 v[144:145], v10 offset:61440
  ds_read_b64_tr_b16 v[148:149], v11 offset:61440
  s_setprio 0
  s_waitcnt lgkmcnt(8)
  v_mfma_f32_32x32x16_bf16 v[40:55], v[160:163], v[72:75], v[40:55]
  ds_read_b64_tr_b16 v[64:65], v5 offset:53248
  ds_read_b64_tr_b16 v[66:67], v5 offset:53760
  ds_read_b64_tr_b16 v[234:235], v8 offset:57344
  ds_read_b64_tr_b16 v[238:239], v9 offset:57344
  buffer_load_dwordx4 v[208:211], v1, s[28:31], s32 offen sc1
  v_mfma_f32_32x32x16_bf16 v[40:55], v[164:167], v[76:79], v[40:55]
  ds_read_b64_tr_b16 v[68:69], v5 offset:55296
  ds_read_b64_tr_b16 v[70:71], v5 offset:55808
  ds_read_b64_tr_b16 v[146:147], v10 offset:57344
  ds_read_b64_tr_b16 v[150:151], v11 offset:57344
  s_setprio 3
  s_waitcnt lgkmcnt(10)
  v_mfma_f32_32x32x16_bf16 v[40:55], v[240:243], v[56:59], v[40:55]
  v_and_b32 v18, s24, v7
  ds_read_b64_tr_b16 v[152:153], v8 offset:59392
  ds_read_b64_tr_b16 v[156:157], v9 offset:59392
  buffer_load_dwordx4 v[212:215], v1, s[28:31], s33 offen sc1
  v_mfma_f32_32x32x16_bf16 v[40:55], v[244:247], v[60:63], v[40:55]
  v_perm_b32 v16, v7, v7, s25
  v_rcp_f32 v20, v18
  ds_read_b64_tr_b16 v[160:161], v10 offset:59392
  ds_read_b64_tr_b16 v[164:165], v11 offset:59392
  s_setprio 2
  s_waitcnt lgkmcnt(6)
  v_mfma_f32_32x32x16_bf16 v[40:55], v[248:251], v[64:67], v[40:55]
  v_perm_b32 v17, v7, v7, s26
  ds_read_b64_tr_b16 v[154:155], v8 offset:4096
  ds_read_b64_tr_b16 v[158:159], v9 offset:4096
  buffer_load_dwordx4 v[216:219], v1, s[28:31], s34 offen sc1
  v_mfma_f32_32x32x16_bf16 v[40:55], v[252:255], v[68:71], v[40:55]
  v_mul_f32 v20, s23, v20
  ds_read_b64_tr_b16 v[162:163], v10 offset:4096
  ds_read_b64_tr_b16 v[166:167], v11 offset:4096
  v_mfma_f32_32x32x16_bf16 v[40:55], v[12:15], v[16:19], v[40:55]
  ds_read_b64_tr_b16 v[240:241], v8 offset:0
  ds_read_b64_tr_b16 v[244:245], v9 offset:0
  ds_read_b64_tr_b16 v[248:249], v10 offset:0
  ds_read_b64_tr_b16 v[252:253], v11 offset:0
  ds_read_b64_tr_b16 v[242:243], v8 offset:2048
  ds_read_b64_tr_b16 v[246:247], v9 offset:2048
  ds_read_b64_tr_b16 v[250:251], v10 offset:2048
  ds_read_b64_tr_b16 v[254:255], v11 offset:2048
  v_lshrrev_b32 v22, 5, v0
  v_and_b32 v23, 31, v0
  v_lshlrev_b32 v10, 3, v23
  v_bfe_u32 v21, v0, 3, 1
  s_setprio 1
  v_mfma_f32_16x16x32_bf16 v[24:27], v[80:83], v[168:171], 0
  v_mul_f32 v40, v20, v40
  v_mul_f32 v41, v20, v41
  v_mul_f32 v42, v20, v42
  v_mfma_f32_16x16x32_bf16 v[28:31], v[84:87], v[168:171], 0
  v_mul_f32 v43, v20, v43
  v_exp_f32 v40, v40
  v_mul_f32 v44, v20, v44
  v_mfma_f32_16x16x32_bf16 v[32:35], v[88:91], v[168:171], 0
  v_exp_f32 v41, v41
  v_mul_f32 v45, v20, v45
  v_exp_f32 v42, v42
  v_mfma_f32_16x16x32_bf16 v[36:39], v[92:95], v[168:171], 0
  v_mul_f32 v46, v20, v46
  v_exp_f32 v43, v43
  v_fma_f32 v40, v40, v18, v18
  s_setprio 0
  v_mfma_f32_16x16x32_bf16 v[24:27], v[96:99], v[172:175], v[24:27]
  v_mul_f32 v47, v20, v47
  v_exp_f32 v44, v44
  v_fma_f32 v41, v41, v18, v18
  v_mfma_f32_16x16x32_bf16 v[28:31], v[100:103], v[172:175], v[28:31]
  v_exp_f32 v45, v45
  v_fma_f32 v42, v42, v18, v18
  v_exp_f32 v46, v46
  v_mfma_f32_16x16x32_bf16 v[32:35], v[104:107], v[172:175], v[32:35]
  v_fma_f32 v43, v43, v18, v18
  v_rcp_f32 v40, v40
  v_exp_f32 v47, v47
  v_mfma_f32_16x16x32_bf16 v[36:39], v[108:111], v[172:175], v[36:39]
  v_fma_f32 v44, v44, v18, v18
  v_rcp_f32 v41, v41
  v_fma_f32 v45, v45, v18, v18
  s_setprio 3
  s_waitcnt vmcnt(11)
  v_mfma_f32_16x16x32_bf16 v[24:27], v[112:115], v[176:179], v[24:27]
  v_rcp_f32 v42, v42
  v_fma_f32 v46, v46, v18, v18
  v_rcp_f32 v43, v43
  v_mfma_f32_16x16x32_bf16 v[28:31], v[116:119], v[176:179], v[28:31]
  v_mul_f32 v40, v40, v48
  v_fma_f32 v47, v47, v18, v18
  v_rcp_f32 v44, v44
  v_mfma_f32_16x16x32_bf16 v[32:35], v[120:123], v[176:179], v[32:35]
  v_mul_f32 v41, v41, v49
  v_rcp_f32 v45, v45
  v_mul_f32 v42, v42, v50
  v_mfma_f32_16x16x32_bf16 v[36:39], v[124:127], v[176:179], v[36:39]
  v_rcp_f32 v46, v46
  v_mul_f32 v43, v43, v51
  v_rcp_f32 v47, v47
  s_setprio 2
  s_waitcnt vmcnt(10)
  v_mfma_f32_16x16x32_bf16 v[24:27], v[128:131], v[180:183], v[24:27]
  v_mul_f32 v44, v44, v52
  v_mul_f32 v45, v45, v53
  v_mul_f32 v46, v46, v54
  v_mfma_f32_16x16x32_bf16 v[28:31], v[132:135], v[180:183], v[28:31]
  v_mul_f32 v47, v47, v55
  v_cvt_pk_bf16_f32 v48, v40, v41
  v_cvt_pk_bf16_f32 v49, v42, v43
  v_mfma_f32_16x16x32_bf16 v[32:35], v[136:139], v[180:183], v[32:35]
  v_cvt_pk_bf16_f32 v50, v44, v45
  v_cvt_pk_bf16_f32 v51, v46, v47
  buffer_store_dwordx4 v[48:51], v2, s[28:31], s18 offen sc1
  s_add_u32 s18, s18, 114688
  v_mfma_f32_16x16x32_bf16 v[36:39], v[140:143], v[180:183], v[36:39]
  s_setprio 1
  s_waitcnt vmcnt(10) lgkmcnt(15)
  v_mfma_f32_16x16x32_bf16 v[24:27], v[232:235], v[184:187], v[24:27]
  v_bfe_u32 v4, v0, 4, 2
  buffer_load_dwordx4 v[220:223], v1, s[28:31], s35 offen sc1
  v_mfma_f32_16x16x32_bf16 v[28:31], v[236:239], v[184:187], v[28:31]
  v_and_b32 v3, 7, v0
  v_mfma_f32_16x16x32_bf16 v[32:35], v[144:147], v[184:187], v[32:35]
  v_xor_b32 v4, v4, v3
  v_mfma_f32_16x16x32_bf16 v[36:39], v[148:151], v[184:187], v[36:39]
  v_lshlrev_b32 v4, 4, v4
  buffer_load_dwordx2 v[12:13], v10, s[28:31], s45 offen sc1
  s_setprio 0
  s_waitcnt vmcnt(11) lgkmcnt(8)
  v_mfma_f32_16x16x32_bf16 v[24:27], v[152:155], v[188:191], v[24:27]
  v_lshl_add_u32 v4, v3, 8, v4
  v_mfma_f32_16x16x32_bf16 v[28:31], v[156:159], v[188:191], v[28:31]
  v_mul_u32_u24 v2, 57344, v21
  v_mfma_f32_16x16x32_bf16 v[32:35], v[160:163], v[188:191], v[32:35]
  v_add3_u32 v4, v4, v2, s17
  v_mfma_f32_16x16x32_bf16 v[36:39], v[164:167], v[188:191], v[36:39]
  v_xor_b32 v5, 64, v4
  s_setprio 3
  s_waitcnt vmcnt(10) lgkmcnt(0)
  v_mfma_f32_16x16x32_bf16 v[24:27], v[240:243], v[192:195], v[24:27]
  v_mul_u32_u24 v2, 55296, v21
  v_mfma_f32_16x16x32_bf16 v[28:31], v[244:247], v[192:195], v[28:31]
  v_subrev_u32 v2, 106496, v2
  v_mfma_f32_16x16x32_bf16 v[32:35], v[248:251], v[192:195], v[32:35]
  v_mfma_f32_16x16x32_bf16 v[36:39], v[252:255], v[192:195], v[36:39]
  s_setprio 2
  s_waitcnt vmcnt(9)
  v_mfma_f32_16x16x32_bf16 v[40:43], v[80:83], v[196:199], 0
  v_cmp_u_f32 vcc, v24, v24
  v_and_b32 v21, 7, v22
  v_mfma_f32_16x16x32_bf16 v[44:47], v[84:87], v[196:199], 0
  v_lshlrev_b32 v7, 4, v21
  v_mfma_f32_16x16x32_bf16 v[48:51], v[88:91], v[196:199], 0
  s_cbranch_vccnz K3_RD0
K3_RB0:
  v_xor_b32 v7, v7, v10
  ds_write_b128 v4, v[24:27] offset:0
  v_mfma_f32_16x16x32_bf16 v[52:55], v[92:95], v[196:199], 0
  v_lshl_add_u32 v7, v21, 8, v7
  s_setprio 1
  s_waitcnt vmcnt(8)
  v_mfma_f32_16x16x32_bf16 v[40:43], v[96:99], v[200:203], v[40:43]
  s_lshr_b32 s9, s4, 2
  v_add_u32 v1, 114688, v1
  buffer_load_dwordx4 v[224:227], v1, s[28:31], s12 offen sc1
  v_mfma_f32_16x16x32_bf16 v[44:47], v[100:103], v[200:203], v[44:47]
  s_mul_i32 s10, s9, 57344
  v_mfma_f32_16x16x32_bf16 v[48:51], v[104:107], v[200:203], v[48:51]
  s_lshl_b32 s9, s9, 11
  v_mfma_f32_16x16x32_bf16 v[52:55], v[108:111], v[200:203], v[52:55]
  s_add_u32 s9, s9, 106496
  buffer_load_dwordx4 v[228:231], v1, s[28:31], s19 offen sc1
  s_setprio 0
  s_waitcnt vmcnt(8)
  v_mfma_f32_16x16x32_bf16 v[40:43], v[112:115], v[204:207], v[40:43]
  v_add_u32 v6, s10, v7
  ds_write_b128 v5, v[28:31] offset:0
  v_mfma_f32_16x16x32_bf16 v[44:47], v[116:119], v[204:207], v[44:47]
  v_add_u32 v7, s9, v7
  v_mfma_f32_16x16x32_bf16 v[48:51], v[120:123], v[204:207], v[48:51]
  v_mul_u32_u24 v9, 896, v22
  buffer_load_dwordx4 v[56:59], v1, s[28:31], s20 offen sc1
  v_mfma_f32_16x16x32_bf16 v[52:55], v[124:127], v[204:207], v[52:55]
  v_lshl_add_u32 v9, v23, 2, v9
  s_setprio 3
  s_waitcnt vmcnt(8)
  v_mfma_f32_16x16x32_bf16 v[40:43], v[128:131], v[208:211], v[40:43]
  v_lshrrev_b32 v8, 3, v22
  s_waitcnt vmcnt(3)
  v_and_b32 v14, v12, v13
  v_and_b32 v14, 1, v14
  v_cmp_ne_u32 vcc, 1, v14
  v_mfma_f32_16x16x32_bf16 v[44:47], v[132:135], v[208:211], v[44:47]
  v_and_b32 v3, 7, v23
  buffer_load_dwordx4 v[60:63], v1, s[28:31], s32 offen sc1
  s_nop 0
  s_nop 0
  v_mfma_f32_16x16x32_bf16 v[48:51], v[136:139], v[208:211], v[48:51]
  v_xor_b32 v8, v8, v3
  s_cbranch_vccnz K3_SLG
K3_OKG:
  v_cvt_pk_bf16_f32 v14, v12, v13
  ds_write_b128 v4, v[32:35] offset:128
  v_mfma_f32_16x16x32_bf16 v[52:55], v[140:143], v[208:211], v[52:55]
  v_lshlrev_b32 v8, 4, v8
  v_lshlrev_b32 v12, 16, v14
  v_and_b32 v13, s24, v14
  s_setprio 2
  v_mfma_f32_16x16x32_bf16 v[40:43], v[232:235], v[212:215], v[40:43]
  v_lshl_add_u32 v8, v23, 8, v8
  buffer_load_dwordx4 v[64:67], v1, s[28:31], s33 offen sc1
  v_mfma_f32_16x16x32_bf16 v[44:47], v[236:239], v[212:215], v[44:47]
  v_lshl_add_u32 v8, v21, 1, v8
  v_mfma_f32_16x16x32_bf16 v[48:51], v[144:147], v[212:215], v[48:51]
  v_add_u32 v8, 49152, v8
  v_mfma_f32_16x16x32_bf16 v[52:55], v[148:151], v[212:215], v[52:55]
  v_mov_b32 v16, 0
  buffer_load_dwordx4 v[68:71], v1, s[28:31], s34 offen sc1
  s_setprio 1
  v_mfma_f32_16x16x32_bf16 v[40:43], v[152:155], v[216:219], v[40:43]
  v_mov_b32 v17, 0
  ds_write_b128 v5, v[36:39] offset:128
  v_mfma_f32_16x16x32_bf16 v[44:47], v[156:159], v[216:219], v[44:47]
  v_mov_b32 v18, 0
  v_mfma_f32_16x16x32_bf16 v[48:51], v[160:163], v[216:219], v[48:51]
  v_mov_b32 v19, 0
  buffer_load_dwordx4 v[72:75], v1, s[28:31], s35 offen sc1
  v_mfma_f32_16x16x32_bf16 v[52:55], v[164:167], v[216:219], v[52:55]
  v_mov_b32 v20, 0
  s_setprio 0
  v_mfma_f32_16x16x32_bf16 v[40:43], v[240:243], v[220:223], v[40:43]
  v_mov_b32 v21, 0
  v_mfma_f32_16x16x32_bf16 v[44:47], v[244:247], v[220:223], v[44:47]
  v_mov_b32 v22, 0
  v_mfma_f32_16x16x32_bf16 v[48:51], v[248:251], v[220:223], v[48:51]
  v_mov_b32 v23, 0
  v_mfma_f32_16x16x32_bf16 v[52:55], v[252:255], v[220:223], v[52:55]
  s_setprio 3
  s_waitcnt vmcnt(6)
  v_mfma_f32_16x16x32_bf16 v[24:27], v[80:83], v[224:227], 0
  v_cmp_u_f32 vcc, v40, v40
  v_mfma_f32_16x16x32_bf16 v[28:31], v[84:87], v[224:227], 0
  v_mfma_f32_16x16x32_bf16 v[32:35], v[88:91], v[224:227], 0
  s_cbranch_vccnz K3_RD1
K3_RB1:
  ds_write_b128 v4, v[40:43] offset:2048
  v_mfma_f32_16x16x32_bf16 v[36:39], v[92:95], v[224:227], 0
  ds_write_b128 v5, v[44:47] offset:2048
  s_setprio 2
  s_waitcnt vmcnt(5)
  v_mfma_f32_16x16x32_bf16 v[24:27], v[96:99], v[228:231], v[24:27]
  ds_write_b128 v4, v[48:51] offset:2176
  v_mfma_f32_16x16x32_bf16 v[28:31], v[100:103], v[228:231], v[28:31]
  ds_write_b128 v5, v[52:55] offset:2176
  v_mfma_f32_16x16x32_bf16 v[32:35], v[104:107], v[228:231], v[32:35]
  v_mfma_f32_16x16x32_bf16 v[36:39], v[108:111], v[228:231], v[36:39]
  s_waitcnt lgkmcnt(0)
  s_barrier
  s_setprio 1
  s_waitcnt vmcnt(4)
  v_mfma_f32_16x16x32_bf16 v[24:27], v[112:115], v[56:59], v[24:27]
  v_add_u32 v1, 114688, v1
  buffer_load_dwordx4 v[168:171], v1, s[28:31], s12 offen sc1
  ds_read_b64 v[196:197], v6 offset:0
  ds_read_b64 v[198:199], v6 offset:6144
  v_mfma_f32_16x16x32_bf16 v[28:31], v[116:119], v[56:59], v[28:31]
  ds_read_b64 v[200:201], v6 offset:12288
  ds_read_b64 v[202:203], v6 offset:18432
  v_mfma_f32_16x16x32_bf16 v[32:35], v[120:123], v[56:59], v[32:35]
  ds_read_b64 v[204:205], v6 offset:24576
  ds_read_b64 v[206:207], v6 offset:30720
  v_mfma_f32_16x16x32_bf16 v[36:39], v[124:127], v[56:59], v[36:39]
  buffer_load_dwordx4 v[172:175], v1, s[28:31], s19 offen sc1
  ds_read_b64 v[208:209], v6 offset:36864
  ds_read_b64 v[210:211], v6 offset:43008
  s_setprio 0
  s_waitcnt vmcnt(5)
  v_mfma_f32_16x16x32_bf16 v[24:27], v[128:131], v[60:63], v[24:27]
  ds_read_u16_d16_hi v16, v8 offset:0
  ds_read_u16_d16_hi v17, v8 offset:128
  v_mfma_f32_16x16x32_bf16 v[28:31], v[132:135], v[60:63], v[28:31]
  v_xor_b32 v3, 32, v8
  ds_read_u16_d16_hi v18, v3 offset:0
  v_mfma_f32_16x16x32_bf16 v[32:35], v[136:139], v[60:63], v[32:35]
  buffer_load_dwordx4 v[176:179], v1, s[28:31], s20 offen sc1
  ds_read_u16_d16_hi v19, v3 offset:128
  v_xor_b32 v3, 64, v8
  v_mfma_f32_16x16x32_bf16 v[36:39], v[140:143], v[60:63], v[36:39]
  ds_read_u16_d16_hi v20, v3 offset:0
  ds_read_u16_d16_hi v21, v3 offset:128
  s_setprio 3
  s_waitcnt vmcnt(5)
  v_mfma_f32_16x16x32_bf16 v[24:27], v[232:235], v[64:67], v[24:27]
  v_xor_b32 v3, 96, v8
  ds_read_u16_d16_hi v22, v3 offset:0
  v_mfma_f32_16x16x32_bf16 v[28:31], v[236:239], v[64:67], v[28:31]
  buffer_load_dwordx4 v[180:183], v1, s[28:31], s32 offen sc1
  ds_read_u16_d16_hi v23, v3 offset:128
  v_mfma_f32_16x16x32_bf16 v[32:35], v[144:147], v[64:67], v[32:35]
  v_mfma_f32_16x16x32_bf16 v[36:39], v[148:151], v[64:67], v[36:39]
  s_setprio 2
  s_waitcnt vmcnt(5)
  v_mfma_f32_16x16x32_bf16 v[24:27], v[152:155], v[68:71], v[24:27]
  buffer_load_dwordx4 v[184:187], v1, s[28:31], s33 offen sc1
  s_waitcnt lgkmcnt(0)
  v_add_f32 v196, v196, v204
  v_mfma_f32_16x16x32_bf16 v[28:31], v[156:159], v[68:71], v[28:31]
  v_add_f32 v197, v197, v205
  v_add_f32 v198, v198, v206
  v_mfma_f32_16x16x32_bf16 v[32:35], v[160:163], v[68:71], v[32:35]
  v_add_f32 v199, v199, v207
  v_add_f32 v200, v200, v208
  v_mfma_f32_16x16x32_bf16 v[36:39], v[164:167], v[68:71], v[36:39]
  buffer_load_dwordx4 v[188:191], v1, s[28:31], s34 offen sc1
  v_add_f32 v201, v201, v209
  v_add_f32 v202, v202, v210
  s_setprio 1
  s_waitcnt vmcnt(6)
  v_mfma_f32_16x16x32_bf16 v[24:27], v[240:243], v[72:75], v[24:27]
  v_add_f32 v203, v203, v211
  v_add_f32 v196, v196, v200
  v_mfma_f32_16x16x32_bf16 v[28:31], v[244:247], v[72:75], v[28:31]
  v_add_f32 v197, v197, v201
  v_add_f32 v198, v198, v202
  v_mfma_f32_16x16x32_bf16 v[32:35], v[248:251], v[72:75], v[32:35]
  buffer_load_dwordx4 v[192:195], v1, s[28:31], s35 offen sc1
  v_add_f32 v199, v199, v203
  v_add_f32 v196, v196, v198
  v_mfma_f32_16x16x32_bf16 v[36:39], v[252:255], v[72:75], v[36:39]
  v_add_f32 v197, v197, v199
  v_fmac_f32 v16, v196, v12
  s_setprio 0
  s_waitcnt vmcnt(6)
  v_mfma_f32_16x16x32_bf16 v[40:43], v[80:83], v[168:171], 0
  v_cmp_u_f32 vcc, v24, v24
  v_fmac_f32 v17, v197, v13
  v_cvt_pk_bf16_f32 v16, v16, v17
  v_mfma_f32_16x16x32_bf16 v[44:47], v[84:87], v[168:171], 0
  buffer_store_dword v16, v9, s[40:43], s27 offen sc1
  s_add_u32 s27, s27, 28672
  v_mfma_f32_16x16x32_bf16 v[48:51], v[88:91], v[168:171], 0
  s_cbranch_vccnz K3_RD2
K3_RB2:
  ds_write_b128 v4, v[24:27] offset:4096
  ds_read_b64 v[196:197], v6 offset:2048
  ds_read_b64 v[198:199], v6 offset:8192
  v_mfma_f32_16x16x32_bf16 v[52:55], v[92:95], v[168:171], 0
  ds_read_b64 v[200:201], v6 offset:14336
  ds_read_b64 v[202:203], v6 offset:20480
  s_setprio 3
  s_waitcnt vmcnt(6)
  v_mfma_f32_16x16x32_bf16 v[40:43], v[96:99], v[172:175], v[40:43]
  ds_read_b64 v[204:205], v6 offset:26624
  ds_read_b64 v[206:207], v6 offset:32768
  v_mfma_f32_16x16x32_bf16 v[44:47], v[100:103], v[172:175], v[44:47]
  ds_read_b64 v[208:209], v6 offset:38912
  ds_read_b64 v[210:211], v6 offset:45056
  v_mfma_f32_16x16x32_bf16 v[48:51], v[104:107], v[172:175], v[48:51]
  ds_write_b128 v5, v[28:31] offset:4096
  v_mfma_f32_16x16x32_bf16 v[52:55], v[108:111], v[172:175], v[52:55]
  s_setprio 2
  s_waitcnt vmcnt(5)
  v_mfma_f32_16x16x32_bf16 v[40:43], v[112:115], v[176:179], v[40:43]
  s_waitcnt lgkmcnt(1)
  v_add_f32 v196, v196, v204
  v_mfma_f32_16x16x32_bf16 v[44:47], v[116:119], v[176:179], v[44:47]
  v_add_f32 v197, v197, v205
  v_add_f32 v198, v198, v206
  v_mfma_f32_16x16x32_bf16 v[48:51], v[120:123], v[176:179], v[48:51]
  ds_write_b128 v4, v[32:35] offset:4224
  v_add_f32 v199, v199, v207
  v_add_f32 v200, v200, v208
  v_mfma_f32_16x16x32_bf16 v[52:55], v[124:127], v[176:179], v[52:55]
  v_add_f32 v201, v201, v209
  v_add_f32 v202, v202, v210
  s_setprio 1
  s_waitcnt vmcnt(4)
  v_mfma_f32_16x16x32_bf16 v[40:43], v[128:131], v[180:183], v[40:43]
  v_add_f32 v203, v203, v211
  v_add_f32 v196, v196, v200
  v_mfma_f32_16x16x32_bf16 v[44:47], v[132:135], v[180:183], v[44:47]
  v_add_f32 v197, v197, v201
  v_add_f32 v198, v198, v202
  v_mfma_f32_16x16x32_bf16 v[48:51], v[136:139], v[180:183], v[48:51]
  ds_write_b128 v5, v[36:39] offset:4224
  v_add_f32 v199, v199, v203
  v_add_f32 v196, v196, v198
  v_mfma_f32_16x16x32_bf16 v[52:55], v[140:143], v[180:183], v[52:55]
  v_add_f32 v197, v197, v199
  v_fmac_f32 v18, v196, v12
  s_setprio 0
  s_waitcnt vmcnt(3)
  v_mfma_f32_16x16x32_bf16 v[40:43], v[232:235], v[184:187], v[40:43]
  v_fmac_f32 v19, v197, v13
  v_cvt_pk_bf16_f32 v18, v18, v19
  v_mfma_f32_16x16x32_bf16 v[44:47], v[236:239], v[184:187], v[44:47]
  buffer_store_dword v18, v9, s[40:43], s27 offen sc1
  s_add_u32 s27, s27, 28672
  v_mfma_f32_16x16x32_bf16 v[48:51], v[144:147], v[184:187], v[48:51]
  v_sub_u32 v4, v4, v2
  v_mfma_f32_16x16x32_bf16 v[52:55], v[148:151], v[184:187], v[52:55]
  v_sub_u32 v5, v5, v2
  s_waitcnt vmcnt(2)
  v_mfma_f32_16x16x32_bf16 v[40:43], v[152:155], v[188:191], v[40:43]
  v_mfma_f32_16x16x32_bf16 v[40:43], v[240:243], v[192:195], v[40:43]
  v_mfma_f32_16x16x32_bf16 v[44:47], v[156:159], v[188:191], v[44:47]
  v_mfma_f32_16x16x32_bf16 v[44:47], v[244:247], v[192:195], v[44:47]
  v_mfma_f32_16x16x32_bf16 v[48:51], v[160:163], v[188:191], v[48:51]
  v_mfma_f32_16x16x32_bf16 v[48:51], v[248:251], v[192:195], v[48:51]
  s_nop 3
  v_cmp_u_f32 vcc, v40, v40
  ds_write_b128 v4, v[40:43] offset:0
  v_mfma_f32_16x16x32_bf16 v[52:55], v[164:167], v[188:191], v[52:55]
  v_mfma_f32_16x16x32_bf16 v[52:55], v[252:255], v[192:195], v[52:55]
  s_cbranch_vccnz K3_RD3
  ds_write_b128 v5, v[44:47] offset:0
  ds_write_b128 v4, v[48:51] offset:128
  s_nop 5
  ds_write_b128 v5, v[52:55] offset:128
K3_RB3:
  s_waitcnt lgkmcnt(0)
  s_barrier
  ds_read_b64 v[56:57], v6 offset:4096
  ds_read_b64 v[58:59], v6 offset:10240
  ds_read_b64 v[60:61], v6 offset:16384
  ds_read_b64 v[62:63], v6 offset:22528
  ds_read_b64 v[64:65], v6 offset:28672
  ds_read_b64 v[66:67], v6 offset:34816
  ds_read_b64 v[68:69], v6 offset:40960
  ds_read_b64 v[70:71], v6 offset:47104
  ds_read_b64 v[196:197], v7 offset:0
  ds_read_b64 v[198:199], v7 offset:6144
  ds_read_b64 v[200:201], v7 offset:12288
  ds_read_b64 v[202:203], v7 offset:18432
  ds_read_b64 v[204:205], v7 offset:24576
  ds_read_b64 v[206:207], v7 offset:30720
  ds_read_b64 v[208:209], v7 offset:36864
  ds_read_b64 v[210:211], v7 offset:43008
  s_waitcnt lgkmcnt(8)
  v_pk_add_f32 v[56:57], v[56:57], v[64:65]
  v_pk_add_f32 v[58:59], v[58:59], v[66:67]
K3C_H2:
  s_cbranch_execz K3C_HE
  s_nop 0
  v_pk_add_f32 v[60:61], v[60:61], v[68:69]
  v_pk_add_f32 v[62:63], v[62:63], v[70:71]
  v_pk_add_f32 v[56:57], v[56:57], v[60:61]
  v_pk_add_f32 v[58:59], v[58:59], v[62:63]
  v_pk_add_f32 v[56:57], v[56:57], v[58:59]
  v_fmac_f32 v20, v56, v12
  v_fmac_f32 v21, v57, v13
  v_cvt_pk_bf16_f32 v20, v20, v21
  buffer_store_dword v20, v9, s[40:43], s27 offen sc1
  s_add_u32 s27, s27, 28672
  s_waitcnt lgkmcnt(0)
  v_pk_add_f32 v[196:197], v[196:197], v[204:205]
  v_pk_add_f32 v[198:199], v[198:199], v[206:207]
  v_pk_add_f32 v[200:201], v[200:201], v[208:209]
  v_pk_add_f32 v[202:203], v[202:203], v[210:211]
  v_pk_add_f32 v[196:197], v[196:197], v[200:201]
  v_pk_add_f32 v[198:199], v[198:199], v[202:203]
  v_pk_add_f32 v[196:197], v[196:197], v[198:199]
  v_fmac_f32 v22, v196, v12
  v_fmac_f32 v23, v197, v13
  v_cvt_pk_bf16_f32 v22, v22, v23
  buffer_store_dword v22, v9, s[40:43], s27 offen sc1
  s_add_u32 s27, s27, 28672
  s_branch K1_END
K3_RD0:
K3_RL0:
  v_and_b32 v11, 63, v0
  s_add_u32 s9, s21, 0
  v_lshl_add_u32 v11, v11, 4, s9
  buffer_load_dwordx4 v[168:171], v11, s[28:31], s12 offen sc1
  buffer_load_dwordx4 v[172:175], v11, s[28:31], s19 offen sc1
  buffer_load_dwordx4 v[176:179], v11, s[28:31], s20 offen sc1
  buffer_load_dwordx4 v[180:183], v11, s[28:31], s32 offen sc1
  buffer_load_dwordx4 v[184:187], v11, s[28:31], s33 offen sc1
  buffer_load_dwordx4 v[188:191], v11, s[28:31], s34 offen sc1
  buffer_load_dwordx4 v[192:195], v11, s[28:31], s35 offen sc1
  s_waitcnt vmcnt(0)
  v_max_u32 v11, v168, v170
  v_max3_u32 v11, v172, v174, v11
  v_max3_u32 v11, v176, v178, v11
  v_max3_u32 v11, v180, v182, v11
  v_max3_u32 v11, v184, v186, v11
  v_max3_u32 v11, v188, v190, v11
  v_max3_u32 v11, v192, v194, v11
  v_cmp_eq_u32 vcc, -1, v11
  s_sub_u32 s14, s14, 1
  s_cmp_lt_i32 s14, 0
  s_nop 2
  s_cbranch_scc1 K3_RE0
  s_cbranch_vccnz K3_RL0
K3_RE0:
  v_mfma_f32_16x16x32_bf16 v[24:27], v[80:83], v[168:171], 0
  v_mfma_f32_16x16x32_bf16 v[28:31], v[84:87], v[168:171], 0
  v_mfma_f32_16x16x32_bf16 v[32:35], v[88:91], v[168:171], 0
  v_mfma_f32_16x16x32_bf16 v[36:39], v[92:95], v[168:171], 0
  v_mfma_f32_16x16x32_bf16 v[24:27], v[96:99], v[172:175], v[24:27]
  v_mfma_f32_16x16x32_bf16 v[28:31], v[100:103], v[172:175], v[28:31]
  v_mfma_f32_16x16x32_bf16 v[32:35], v[104:107], v[172:175], v[32:35]
  v_mfma_f32_16x16x32_bf16 v[36:39], v[108:111], v[172:175], v[36:39]
  v_mfma_f32_16x16x32_bf16 v[24:27], v[112:115], v[176:179], v[24:27]
  v_mfma_f32_16x16x32_bf16 v[28:31], v[116:119], v[176:179], v[28:31]
  v_mfma_f32_16x16x32_bf16 v[32:35], v[120:123], v[176:179], v[32:35]
  v_mfma_f32_16x16x32_bf16 v[36:39], v[124:127], v[176:179], v[36:39]
  v_mfma_f32_16x16x32_bf16 v[24:27], v[128:131], v[180:183], v[24:27]
  v_mfma_f32_16x16x32_bf16 v[28:31], v[132:135], v[180:183], v[28:31]
  v_mfma_f32_16x16x32_bf16 v[32:35], v[136:139], v[180:183], v[32:35]
  v_mfma_f32_16x16x32_bf16 v[36:39], v[140:143], v[180:183], v[36:39]
  v_mfma_f32_16x16x32_bf16 v[24:27], v[232:235], v[184:187], v[24:27]
  v_mfma_f32_16x16x32_bf16 v[28:31], v[236:239], v[184:187], v[28:31]
  v_mfma_f32_16x16x32_bf16 v[32:35], v[144:147], v[184:187], v[32:35]
  v_mfma_f32_16x16x32_bf16 v[36:39], v[148:151], v[184:187], v[36:39]
  v_mfma_f32_16x16x32_bf16 v[24:27], v[152:155], v[188:191], v[24:27]
  v_mfma_f32_16x16x32_bf16 v[28:31], v[156:159], v[188:191], v[28:31]
  v_mfma_f32_16x16x32_bf16 v[32:35], v[160:163], v[188:191], v[32:35]
  v_mfma_f32_16x16x32_bf16 v[36:39], v[164:167], v[188:191], v[36:39]
  v_mfma_f32_16x16x32_bf16 v[24:27], v[240:243], v[192:195], v[24:27]
  v_mfma_f32_16x16x32_bf16 v[28:31], v[244:247], v[192:195], v[28:31]
  v_mfma_f32_16x16x32_bf16 v[32:35], v[248:251], v[192:195], v[32:35]
  v_mfma_f32_16x16x32_bf16 v[36:39], v[252:255], v[192:195], v[36:39]
  s_nop 7
  s_nop 7
  s_branch K3_RB0
K3_RD1:
K3_RL1:
  v_and_b32 v11, 63, v0
  s_add_u32 s9, s21, 114688
  v_lshl_add_u32 v11, v11, 4, s9
  buffer_load_dwordx4 v[196:199], v11, s[28:31], s12 offen sc1
  buffer_load_dwordx4 v[200:203], v11, s[28:31], s19 offen sc1
  buffer_load_dwordx4 v[204:207], v11, s[28:31], s20 offen sc1
  buffer_load_dwordx4 v[208:211], v11, s[28:31], s32 offen sc1
  buffer_load_dwordx4 v[212:215], v11, s[28:31], s33 offen sc1
  buffer_load_dwordx4 v[216:219], v11, s[28:31], s34 offen sc1
  buffer_load_dwordx4 v[220:223], v11, s[28:31], s35 offen sc1
  s_waitcnt vmcnt(0)
  v_max_u32 v11, v196, v198
  v_max3_u32 v11, v200, v202, v11
  v_max3_u32 v11, v204, v206, v11
  v_max3_u32 v11, v208, v210, v11
  v_max3_u32 v11, v212, v214, v11
  v_max3_u32 v11, v216, v218, v11
  v_max3_u32 v11, v220, v222, v11
  v_cmp_eq_u32 vcc, -1, v11
  s_sub_u32 s14, s14, 1
  s_cmp_lt_i32 s14, 0
  s_nop 2
  s_cbranch_scc1 K3_RE1
  s_cbranch_vccnz K3_RL1
K3_RE1:
  v_mfma_f32_16x16x32_bf16 v[40:43], v[80:83], v[196:199], 0
  v_mfma_f32_16x16x32_bf16 v[44:47], v[84:87], v[196:199], 0
  v_mfma_f32_16x16x32_bf16 v[48:51], v[88:91], v[196:199], 0
  v_mfma_f32_16x16x32_bf16 v[52:55], v[92:95], v[196:199], 0
  v_mfma_f32_16x16x32_bf16 v[40:43], v[96:99], v[200:203], v[40:43]
  v_mfma_f32_16x16x32_bf16 v[44:47], v[100:103], v[200:203], v[44:47]
  v_mfma_f32_16x16x32_bf16 v[48:51], v[104:107], v[200:203], v[48:51]
  v_mfma_f32_16x16x32_bf16 v[52:55], v[108:111], v[200:203], v[52:55]
  v_mfma_f32_16x16x32_bf16 v[40:43], v[112:115], v[204:207], v[40:43]
  v_mfma_f32_16x16x32_bf16 v[44:47], v[116:119], v[204:207], v[44:47]
  v_mfma_f32_16x16x32_bf16 v[48:51], v[120:123], v[204:207], v[48:51]
  v_mfma_f32_16x16x32_bf16 v[52:55], v[124:127], v[204:207], v[52:55]
  v_mfma_f32_16x16x32_bf16 v[40:43], v[128:131], v[208:211], v[40:43]
  v_mfma_f32_16x16x32_bf16 v[44:47], v[132:135], v[208:211], v[44:47]
  v_mfma_f32_16x16x32_bf16 v[48:51], v[136:139], v[208:211], v[48:51]
  v_mfma_f32_16x16x32_bf16 v[52:55], v[140:143], v[208:211], v[52:55]
  v_mfma_f32_16x16x32_bf16 v[40:43], v[232:235], v[212:215], v[40:43]
  v_mfma_f32_16x16x32_bf16 v[44:47], v[236:239], v[212:215], v[44:47]
  v_mfma_f32_16x16x32_bf16 v[48:51], v[144:147], v[212:215], v[48:51]
  v_mfma_f32_16x16x32_bf16 v[52:55], v[148:151], v[212:215], v[52:55]
  v_mfma_f32_16x16x32_bf16 v[40:43], v[152:155], v[216:219], v[40:43]
  v_mfma_f32_16x16x32_bf16 v[44:47], v[156:159], v[216:219], v[44:47]
  v_mfma_f32_16x16x32_bf16 v[48:51], v[160:163], v[216:219], v[48:51]
  v_mfma_f32_16x16x32_bf16 v[52:55], v[164:167], v[216:219], v[52:55]
  v_mfma_f32_16x16x32_bf16 v[40:43], v[240:243], v[220:223], v[40:43]
  v_mfma_f32_16x16x32_bf16 v[44:47], v[244:247], v[220:223], v[44:47]
  v_mfma_f32_16x16x32_bf16 v[48:51], v[248:251], v[220:223], v[48:51]
  v_mfma_f32_16x16x32_bf16 v[52:55], v[252:255], v[220:223], v[52:55]
  s_nop 7
  s_nop 7
  s_branch K3_RB1
K3_RD2:
K3_RL2:
  v_and_b32 v11, 63, v0
  s_add_u32 s9, s21, 229376
  v_lshl_add_u32 v11, v11, 4, s9
  buffer_load_dwordx4 v[224:227], v11, s[28:31], s12 offen sc1
  buffer_load_dwordx4 v[228:231], v11, s[28:31], s19 offen sc1
  buffer_load_dwordx4 v[56:59], v11, s[28:31], s20 offen sc1
  buffer_load_dwordx4 v[60:63], v11, s[28:31], s32 offen sc1
  buffer_load_dwordx4 v[64:67], v11, s[28:31], s33 offen sc1
  buffer_load_dwordx4 v[68:71], v11, s[28:31], s34 offen sc1
  buffer_load_dwordx4 v[72:75], v11, s[28:31], s35 offen sc1
  s_waitcnt vmcnt(0)
  v_max_u32 v11, v224, v226
  v_max3_u32 v11, v228, v230, v11
  v_max3_u32 v11, v56, v58, v11
  v_max3_u32 v11, v60, v62, v11
  v_max3_u32 v11, v64, v66, v11
  v_max3_u32 v11, v68, v70, v11
  v_max3_u32 v11, v72, v74, v11
  v_cmp_eq_u32 vcc, -1, v11
  s_sub_u32 s14, s14, 1
  s_cmp_lt_i32 s14, 0
  s_nop 2
  s_cbranch_scc1 K3_RE2
  s_cbranch_vccnz K3_RL2
K3_RE2:
  v_mfma_f32_16x16x32_bf16 v[24:27], v[80:83], v[224:227], 0
  v_mfma_f32_16x16x32_bf16 v[28:31], v[84:87], v[224:227], 0
  v_mfma_f32_16x16x32_bf16 v[32:35], v[88:91], v[224:227], 0
  v_mfma_f32_16x16x32_bf16 v[36:39], v[92:95], v[224:227], 0
  v_mfma_f32_16x16x32_bf16 v[24:27], v[96:99], v[228:231], v[24:27]
  v_mfma_f32_16x16x32_bf16 v[28:31], v[100:103], v[228:231], v[28:31]
  v_mfma_f32_16x16x32_bf16 v[32:35], v[104:107], v[228:231], v[32:35]
  v_mfma_f32_16x16x32_bf16 v[36:39], v[108:111], v[228:231], v[36:39]
  v_mfma_f32_16x16x32_bf16 v[24:27], v[112:115], v[56:59], v[24:27]
  v_mfma_f32_16x16x32_bf16 v[28:31], v[116:119], v[56:59], v[28:31]
  v_mfma_f32_16x16x32_bf16 v[32:35], v[120:123], v[56:59], v[32:35]
  v_mfma_f32_16x16x32_bf16 v[36:39], v[124:127], v[56:59], v[36:39]
  v_mfma_f32_16x16x32_bf16 v[24:27], v[128:131], v[60:63], v[24:27]
  v_mfma_f32_16x16x32_bf16 v[28:31], v[132:135], v[60:63], v[28:31]
  v_mfma_f32_16x16x32_bf16 v[32:35], v[136:139], v[60:63], v[32:35]
  v_mfma_f32_16x16x32_bf16 v[36:39], v[140:143], v[60:63], v[36:39]
  v_mfma_f32_16x16x32_bf16 v[24:27], v[232:235], v[64:67], v[24:27]
  v_mfma_f32_16x16x32_bf16 v[28:31], v[236:239], v[64:67], v[28:31]
  v_mfma_f32_16x16x32_bf16 v[32:35], v[144:147], v[64:67], v[32:35]
  v_mfma_f32_16x16x32_bf16 v[36:39], v[148:151], v[64:67], v[36:39]
  v_mfma_f32_16x16x32_bf16 v[24:27], v[152:155], v[68:71], v[24:27]
  v_mfma_f32_16x16x32_bf16 v[28:31], v[156:159], v[68:71], v[28:31]
  v_mfma_f32_16x16x32_bf16 v[32:35], v[160:163], v[68:71], v[32:35]
  v_mfma_f32_16x16x32_bf16 v[36:39], v[164:167], v[68:71], v[36:39]
  v_mfma_f32_16x16x32_bf16 v[24:27], v[240:243], v[72:75], v[24:27]
  v_mfma_f32_16x16x32_bf16 v[28:31], v[244:247], v[72:75], v[28:31]
  v_mfma_f32_16x16x32_bf16 v[32:35], v[248:251], v[72:75], v[32:35]
  v_mfma_f32_16x16x32_bf16 v[36:39], v[252:255], v[72:75], v[36:39]
  s_nop 7
  s_nop 7
  s_branch K3_RB2
K3_RD3:
K3_RL3:
  v_and_b32 v11, 63, v0
  s_add_u32 s9, s21, 344064
  v_lshl_add_u32 v11, v11, 4, s9
  buffer_load_dwordx4 v[168:171], v11, s[28:31], s12 offen sc1
  buffer_load_dwordx4 v[172:175], v11, s[28:31], s19 offen sc1
  buffer_load_dwordx4 v[176:179], v11, s[28:31], s20 offen sc1
  buffer_load_dwordx4 v[180:183], v11, s[28:31], s32 offen sc1
  buffer_load_dwordx4 v[184:187], v11, s[28:31], s33 offen sc1
  buffer_load_dwordx4 v[188:191], v11, s[28:31], s34 offen sc1
  buffer_load_dwordx4 v[192:195], v11, s[28:31], s35 offen sc1
  s_waitcnt vmcnt(0)
  v_max_u32 v11, v168, v170
  v_max3_u32 v11, v172, v174, v11
  v_max3_u32 v11, v176, v178, v11
  v_max3_u32 v11, v180, v182, v11
  v_max3_u32 v11, v184, v186, v11
  v_max3_u32 v11, v188, v190, v11
  v_max3_u32 v11, v192, v194, v11
  v_cmp_eq_u32 vcc, -1, v11
  s_sub_u32 s14, s14, 1
  s_cmp_lt_i32 s14, 0
  s_nop 2
  s_cbranch_scc1 K3_RE3
  s_cbranch_vccnz K3_RL3
K3_RE3:
  v_mfma_f32_16x16x32_bf16 v[40:43], v[80:83], v[168:171], 0
  v_mfma_f32_16x16x32_bf16 v[44:47], v[84:87], v[168:171], 0
  v_mfma_f32_16x16x32_bf16 v[48:51], v[88:91], v[168:171], 0
  v_mfma_f32_16x16x32_bf16 v[52:55], v[92:95], v[168:171], 0
  v_mfma_f32_16x16x32_bf16 v[40:43], v[96:99], v[172:175], v[40:43]
  v_mfma_f32_16x16x32_bf16 v[44:47], v[100:103], v[172:175], v[44:47]
  v_mfma_f32_16x16x32_bf16 v[48:51], v[104:107], v[172:175], v[48:51]
  v_mfma_f32_16x16x32_bf16 v[52:55], v[108:111], v[172:175], v[52:55]
  v_mfma_f32_16x16x32_bf16 v[40:43], v[112:115], v[176:179], v[40:43]
  v_mfma_f32_16x16x32_bf16 v[44:47], v[116:119], v[176:179], v[44:47]
  v_mfma_f32_16x16x32_bf16 v[48:51], v[120:123], v[176:179], v[48:51]
  v_mfma_f32_16x16x32_bf16 v[52:55], v[124:127], v[176:179], v[52:55]
  v_mfma_f32_16x16x32_bf16 v[40:43], v[128:131], v[180:183], v[40:43]
  v_mfma_f32_16x16x32_bf16 v[44:47], v[132:135], v[180:183], v[44:47]
  v_mfma_f32_16x16x32_bf16 v[48:51], v[136:139], v[180:183], v[48:51]
  v_mfma_f32_16x16x32_bf16 v[52:55], v[140:143], v[180:183], v[52:55]
  v_mfma_f32_16x16x32_bf16 v[40:43], v[232:235], v[184:187], v[40:43]
  v_mfma_f32_16x16x32_bf16 v[44:47], v[236:239], v[184:187], v[44:47]
  v_mfma_f32_16x16x32_bf16 v[48:51], v[144:147], v[184:187], v[48:51]
  v_mfma_f32_16x16x32_bf16 v[52:55], v[148:151], v[184:187], v[52:55]
  v_mfma_f32_16x16x32_bf16 v[40:43], v[152:155], v[188:191], v[40:43]
  v_mfma_f32_16x16x32_bf16 v[44:47], v[156:159], v[188:191], v[44:47]
  v_mfma_f32_16x16x32_bf16 v[48:51], v[160:163], v[188:191], v[48:51]
  v_mfma_f32_16x16x32_bf16 v[52:55], v[164:167], v[188:191], v[52:55]
  v_mfma_f32_16x16x32_bf16 v[40:43], v[240:243], v[192:195], v[40:43]
  v_mfma_f32_16x16x32_bf16 v[44:47], v[244:247], v[192:195], v[44:47]
  v_mfma_f32_16x16x32_bf16 v[48:51], v[248:251], v[192:195], v[48:51]
  v_mfma_f32_16x16x32_bf16 v[52:55], v[252:255], v[192:195], v[52:55]
  s_nop 4
  ds_write_b128 v4, v[40:43] offset:0
  ds_write_b128 v5, v[44:47] offset:0
  ds_write_b128 v4, v[48:51] offset:128
  ds_write_b128 v5, v[52:55] offset:128
  s_nop 7
  s_nop 7
  s_branch K3_RB3
K3_SLX:
  s_sub_u32 s14, s14, 1
  s_cmp_lt_i32 s14, 0
  s_cbranch_scc1 K3_OKX
  s_sleep 4
  buffer_load_dword v26, v25, s[28:31], s11 offen sc1
  s_waitcnt vmcnt(0)
  v_cmp_eq_u32 vcc, 0, v26
  s_nop 4
  s_cbranch_vccnz K3_SLX
  s_branch K3_OKX
K3_SLB00:
  s_sub_u32 s14, s14, 1
  s_cmp_lt_i32 s14, 0
  s_cbranch_scc1 K3_OKB00
  s_sleep 4
  s_mov_b32 s9, m0
  s_mov_b32 s10, s15
  s_add_u32 m0, s13, 0
  s_mov_b32 s15, 0
  buffer_load_dwordx4 v22, s[28:31], s15 offen sc1 lds
  s_add_u32 m0, s13, 8192
  s_mov_b32 s15, 8192
  buffer_load_dwordx4 v22, s[28:31], s15 offen sc1 lds
  s_mov_b32 m0, s9
  s_mov_b32 s15, s10
  s_waitcnt vmcnt(0)
  ds_read_b128 v[116:119], v112 offset:0
  ds_read_b128 v[120:123], v112 offset:8192
  s_waitcnt lgkmcnt(0)
  v_max_u32 v116, v116, v118
  v_max3_u32 v116, v120, v122, v116
  v_cmp_eq_u32 vcc, -1, v116
  s_nop 4
  s_cbranch_vccnz K3_SLB00
  s_branch K3_OKB00
K3_SLY:
  s_sub_u32 s14, s14, 1
  s_cmp_lt_i32 s14, 0
  s_cbranch_scc1 K3_OKY
  s_sleep 4
  buffer_load_dword v81, v80, s[28:31], s11 offen sc1
  s_waitcnt vmcnt(0)
  v_cmp_eq_u32 vcc, 0, v81
  s_nop 4
  s_cbranch_vccnz K3_SLY
  s_branch K3_OKY
K3_SLB06:
  s_sub_u32 s14, s14, 1
  s_cmp_lt_i32 s14, 0
  s_cbranch_scc1 K3_OKB06
  s_sleep 4
  s_mov_b32 s9, m0
  s_mov_b32 s10, s15
  s_add_u32 m0, s13, 49152
  s_mov_b32 s15, 49152
  buffer_load_dwordx4 v22, s[28:31], s15 offen sc1 lds
  s_mov_b32 m0, s9
  s_mov_b32 s15, s10
  s_waitcnt vmcnt(0)
  ds_read_b128 v[116:119], v112 offset:49152
  s_waitcnt lgkmcnt(0)
  v_max_u32 v116, v116, v118
  v_cmp_eq_u32 vcc, -1, v116
  s_nop 4
  s_cbranch_vccnz K3_SLB06
  s_branch K3_OKB06
K3_SLB02:
  s_sub_u32 s14, s14, 1
  s_cmp_lt_i32 s14, 0
  s_cbranch_scc1 K3_OKB02
  s_sleep 4
  s_mov_b32 s9, m0
  s_mov_b32 s10, s15
  s_add_u32 m0, s13, 16384
  s_mov_b32 s15, 16384
  buffer_load_dwordx4 v22, s[28:31], s15 offen sc1 lds
  s_add_u32 m0, s13, 24576
  s_add_u32 s15, s89, 0
  s_sub_u32 s47, s15, 24576
  s_min_u32 s15, s15, s47
  s_add_u32 s15, s15, 24576
  buffer_load_dwordx4 v22, s[28:31], s15 offen sc1 lds
  s_mov_b32 m0, s9
  s_mov_b32 s15, s10
  s_waitcnt vmcnt(0)
  ds_read_b128 v[116:119], v112 offset:16384
  ds_read_b128 v[120:123], v112 offset:24576
  s_waitcnt lgkmcnt(0)
  v_max_u32 v116, v116, v118
  v_max3_u32 v116, v120, v122, v116
  v_cmp_eq_u32 vcc, -1, v116
  s_nop 4
  s_cbranch_vccnz K3_SLB02
  s_branch K3_OKB02
K3_SLB04:
  s_sub_u32 s14, s14, 1
  s_cmp_lt_i32 s14, 0
  s_cbranch_scc1 K3_OKB04
  s_sleep 4
  s_mov_b32 s9, m0
  s_mov_b32 s10, s15
  s_add_u32 m0, s13, 32768
  s_add_u32 s15, s89, 8192
  s_sub_u32 s47, s15, 24576
  s_min_u32 s15, s15, s47
  s_add_u32 s15, s15, 24576
  buffer_load_dwordx4 v22, s[28:31], s15 offen sc1 lds
  s_add_u32 m0, s13, 40960
  s_add_u32 s15, s89, 16384
  s_sub_u32 s47, s15, 24576
  s_min_u32 s15, s15, s47
  s_add_u32 s15, s15, 24576
  buffer_load_dwordx4 v22, s[28:31], s15 offen sc1 lds
  s_mov_b32 m0, s9
  s_mov_b32 s15, s10
  s_waitcnt vmcnt(0)
  ds_read_b128 v[116:119], v112 offset:32768
  ds_read_b128 v[120:123], v112 offset:40960
  s_waitcnt lgkmcnt(0)
  v_max_u32 v116, v116, v118
  v_max3_u32 v116, v120, v122, v116
  v_cmp_eq_u32 vcc, -1, v116
  s_nop 4
  s_cbranch_vccnz K3_SLB04
  s_branch K3_OKB04
K3_SLB10:
  s_sub_u32 s14, s14, 1
  s_cmp_lt_i32 s14, 0
  s_cbranch_scc1 K3_OKB10
  s_sleep 4
  s_mov_b32 s9, m0
  s_mov_b32 s10, s15
  s_add_u32 m0, s13, 106496
  s_mov_b32 s15, 57344
  buffer_load_dwordx4 v22, s[28:31], s15 offen sc1 lds
  s_add_u32 m0, s13, 114688
  s_mov_b32 s15, 65536
  buffer_load_dwordx4 v22, s[28:31], s15 offen sc1 lds
  s_add_u32 m0, s13, 122880
  s_mov_b32 s15, 73728
  buffer_load_dwordx4 v22, s[28:31], s15 offen sc1 lds
  s_add_u32 m0, s13, 131072
  s_add_u32 s15, s89, 0
  s_sub_u32 s47, s15, 24576
  s_min_u32 s15, s15, s47
  s_add_u32 s15, s15, 81920
  buffer_load_dwordx4 v22, s[28:31], s15 offen sc1 lds
  s_add_u32 m0, s13, 139264
  s_add_u32 s15, s89, 8192
  s_sub_u32 s47, s15, 24576
  s_min_u32 s15, s15, s47
  s_add_u32 s15, s15, 81920
  buffer_load_dwordx4 v22, s[28:31], s15 offen sc1 lds
  s_add_u32 m0, s13, 147456
  s_add_u32 s15, s89, 16384
  s_sub_u32 s47, s15, 24576
  s_min_u32 s15, s15, s47
  s_add_u32 s15, s15, 81920
  buffer_load_dwordx4 v22, s[28:31], s15 offen sc1 lds
  s_add_u32 m0, s13, 155648
  s_mov_b32 s15, 106496
  buffer_load_dwordx4 v22, s[28:31], s15 offen sc1 lds
  s_mov_b32 m0, s9
  s_mov_b32 s15, s10
  s_waitcnt vmcnt(0)
  ds_read_b128 v[116:119], v112 offset:0
  ds_read_b128 v[120:123], v112 offset:8192
  ds_read_b128 v[124:127], v112 offset:16384
  ds_read_b128 v[128:131], v112 offset:24576
  ds_read_b128 v[132:135], v112 offset:32768
  ds_read_b128 v[136:139], v112 offset:40960
  ds_read_b128 v[140:143], v112 offset:49152
  s_waitcnt lgkmcnt(0)
  v_max_u32 v116, v116, v118
  v_max3_u32 v116, v120, v122, v116
  v_max3_u32 v116, v124, v126, v116
  v_max3_u32 v116, v128, v130, v116
  v_max3_u32 v116, v132, v134, v116
  v_max3_u32 v116, v136, v138, v116
  v_max3_u32 v116, v140, v142, v116
  v_cmp_eq_u32 vcc, -1, v116
  s_nop 4
  s_cbranch_vccnz K3_SLB10
  s_branch K3_OKB10
K3_SLS2:
  s_sub_u32 s14, s14, 1
  s_cmp_lt_i32 s14, 0
  s_cbranch_scc1 K3_OKS2
  s_sleep 4
  buffer_load_dword v6, v21, s[28:31], s22 offen offset:256 sc1
  buffer_load_dword v7, v21, s[28:31], s22 offen offset:384 sc1
  s_waitcnt vmcnt(0)
  v_min_u32 v22, v6, v7
  v_cmp_eq_u32 vcc, 0, v22
  s_nop 4
  s_cbranch_vccnz K3_SLS2
  s_branch K3_OKS2
K3_SLS:
  s_sub_u32 s14, s14, 1
  s_cmp_lt_i32 s14, 0
  s_cbranch_scc1 K3_OKS
  s_sleep 4
  buffer_load_dwordx2 v[12:13], v15, s[28:31], s46 offen sc1
  buffer_load_dword v19, v21, s[28:31], s22 offen offset:0 sc1
  buffer_load_dword v3, v21, s[28:31], s22 offen offset:128 sc1
  s_waitcnt vmcnt(0)
  v_min3_u32 v20, v19, v3, v12
  v_cmp_eq_u32 vcc, 0, v20
  s_nop 4
  s_cbranch_vccnz K3_SLS
  s_branch K3_OKS
K3_SLF:
  s_sub_u32 s14, s14, 1
  s_cmp_lt_i32 s14, 0
  s_cbranch_scc1 K3_OKF
  s_sleep 4
  buffer_load_dword v22, v21, s[28:31], s22 offen sc1
  s_waitcnt vmcnt(0)
  v_cmp_eq_u32 vcc, 0, v22
  s_nop 4
  s_cbranch_vccnz K3_SLF
  s_branch K3_OKF
K3_SLG:
  s_sub_u32 s14, s14, 1
  s_cmp_lt_i32 s14, 0
  s_cbranch_scc1 K3_OKG
  s_sleep 4
  buffer_load_dwordx2 v[12:13], v10, s[28:31], s45 offen sc1
  s_waitcnt vmcnt(0)
  v_and_b32 v14, v12, v13
  v_and_b32 v14, 1, v14
  v_cmp_ne_u32 vcc, 1, v14
  s_nop 4
  s_cbranch_vccnz K3_SLG
  s_branch K3_OKG
K1_SPARE:
  s_sub_u32 s3, s2, 224
  s_mov_b32 s100, s3
  s_mov_b32 s55, 0xffff0000
  v_min_u32 v130, 11, v1
  v_lshlrev_b32 v130, 4, v130
  s_cmp_ge_u32 s3, 18
  s_nop 0
  s_cbranch_scc1 K1_CS
K1_MOD:
  v_and_b32 v3, 15, v0
  v_lshrrev_b32 v4, 4, v0
  v_mul_u32_u24 v5, 10752, v4
  v_lshl_add_u32 v5, v3, 4, v5
  v_add_u32 v6, 5376, v5
  v_lshlrev_b32 v7, 2, v4
  s_lshl_b32 s40, s100, 8
  s_mov_b32 s34, 2408448
  s_mov_b32 s35, 0x00020000
  s_mov_b32 s38, 0x05040100
  s_mov_b32 s39, 0x07060302
  s_waitcnt lgkmcnt(0)
  s_mov_b32 s32, s96
  s_mov_b32 s33, s97
  global_load_dword v168, v7, s[98:99] offset:0
  global_load_dword v169, v7, s[98:99] offset:128
  global_load_dword v170, v7, s[98:99] offset:256
  global_load_dword v171, v7, s[98:99] offset:384
  global_load_dword v172, v7, s[98:99] offset:512
  global_load_dword v173, v7, s[98:99] offset:640
  global_load_dword v174, v7, s[98:99] offset:768
  buffer_load_dwordx4 v[176:179], v5, s[32:35], s40 offen
  buffer_load_dwordx4 v[180:183], v6, s[32:35], s40 offen
  s_add_u32 s40, s40, 344064
  buffer_load_dwordx4 v[184:187], v5, s[32:35], s40 offen
  buffer_load_dwordx4 v[188:191], v6, s[32:35], s40 offen
  s_add_u32 s40, s40, 344064
  buffer_load_dwordx4 v[192:195], v5, s[32:35], s40 offen
  buffer_load_dwordx4 v[196:199], v6, s[32:35], s40 offen
  s_add_u32 s40, s40, 344064
  buffer_load_dwordx4 v[200:203], v5, s[32:35], s40 offen
  buffer_load_dwordx4 v[204:207], v6, s[32:35], s40 offen
  s_add_u32 s40, s40, 344064
  buffer_load_dwordx4 v[208:211], v5, s[32:35], s40 offen
  buffer_load_dwordx4 v[212:215], v6, s[32:35], s40 offen
  s_add_u32 s40, s40, 344064
  buffer_load_dwordx4 v[216:219], v5, s[32:35], s40 offen
  buffer_load_dwordx4 v[220:223], v6, s[32:35], s40 offen
  s_add_u32 s40, s40, 344064
  buffer_load_dwordx4 v[224:227], v5, s[32:35], s40 offen
  buffer_load_dwordx4 v[228:231], v6, s[32:35], s40 offen
  s_add_u32 s40, s40, 344064
  s_waitcnt vmcnt(14)
  v_lshlrev_b32 v96, 16, v168
  v_and_b32 v97, s55, v168
  v_lshlrev_b32 v98, 16, v169
  v_and_b32 v99, s55, v169
  v_lshlrev_b32 v100, 16, v170
  v_and_b32 v101, s55, v170
  v_lshlrev_b32 v102, 16, v171
  v_and_b32 v103, s55, v171
  v_lshlrev_b32 v104, 16, v172
  v_and_b32 v105, s55, v172
  v_lshlrev_b32 v106, 16, v173
  v_and_b32 v107, s55, v173
  v_lshlrev_b32 v108, 16, v174
  v_and_b32 v109, s55, v174
  v_mul_f32 v112, 0xbfb8aa3b, v96
  v_mul_f32 v113, 0xbfb8aa3b, v97
  v_mul_f32 v114, 0xbfb8aa3b, v98
  v_mul_f32 v115, 0xbfb8aa3b, v99
  v_mul_f32 v116, 0xbfb8aa3b, v100
  v_mul_f32 v117, 0xbfb8aa3b, v101
  v_mul_f32 v118, 0xbfb8aa3b, v102
  v_mul_f32 v119, 0xbfb8aa3b, v103
  v_mul_f32 v120, 0xbfb8aa3b, v104
  v_mul_f32 v121, 0xbfb8aa3b, v105
  v_mul_f32 v122, 0xbfb8aa3b, v106
  v_mul_f32 v123, 0xbfb8aa3b, v107
  v_mul_f32 v124, 0xbfb8aa3b, v108
  v_mul_f32 v125, 0xbfb8aa3b, v109
  v_exp_f32 v112, v112
  v_exp_f32 v113, v113
  v_exp_f32 v114, v114
  v_exp_f32 v115, v115
  v_exp_f32 v116, v116
  v_exp_f32 v117, v117
  v_exp_f32 v118, v118
  v_exp_f32 v119, v119
  v_exp_f32 v120, v120
  v_exp_f32 v121, v121
  v_exp_f32 v122, v122
  v_exp_f32 v123, v123
  v_exp_f32 v124, v124
  v_exp_f32 v125, v125
  v_add_f32 v112, 1.0, v112
  v_add_f32 v113, 1.0, v113
  v_add_f32 v114, 1.0, v114
  v_add_f32 v115, 1.0, v115
  v_add_f32 v116, 1.0, v116
  v_add_f32 v117, 1.0, v117
  v_add_f32 v118, 1.0, v118
  v_add_f32 v119, 1.0, v119
  v_add_f32 v120, 1.0, v120
  v_add_f32 v121, 1.0, v121
  v_add_f32 v122, 1.0, v122
  v_add_f32 v123, 1.0, v123
  v_add_f32 v124, 1.0, v124
  v_add_f32 v125, 1.0, v125
  v_rcp_f32 v112, v112
  v_rcp_f32 v113, v113
  v_rcp_f32 v114, v114
  v_rcp_f32 v115, v115
  v_rcp_f32 v116, v116
  v_rcp_f32 v117, v117
  v_rcp_f32 v118, v118
  v_rcp_f32 v119, v119
  v_rcp_f32 v120, v120
  v_rcp_f32 v121, v121
  v_rcp_f32 v122, v122
  v_rcp_f32 v123, v123
  v_rcp_f32 v124, v124
  v_rcp_f32 v125, v125
  v_mul_f32 v96, v96, v112
  v_mul_f32 v97, v97, v113
  v_mul_f32 v98, v98, v114
  v_mul_f32 v99, v99, v115
  v_mul_f32 v100, v100, v116
  v_mul_f32 v101, v101, v117
  v_mul_f32 v102, v102, v118
  v_mul_f32 v103, v103, v119
  v_mul_f32 v104, v104, v120
  v_mul_f32 v105, v105, v121
  v_mul_f32 v106, v106, v122
  v_mul_f32 v107, v107, v123
  v_mul_f32 v108, v108, v124
  v_mul_f32 v109, v109, v125
  v_cvt_pk_bf16_f32 v24, v96, v97
  v_cvt_pk_bf16_f32 v25, v98, v99
  v_cvt_pk_bf16_f32 v26, v100, v101
  v_cvt_pk_bf16_f32 v27, v102, v103
  v_cvt_pk_bf16_f32 v28, v104, v105
  v_cvt_pk_bf16_f32 v29, v106, v107
  v_cvt_pk_bf16_f32 v30, v108, v109
  s_waitcnt vmcnt(12)
  v_perm_b32 v96, v180, v176, s38
  v_perm_b32 v97, v180, v176, s39
  v_perm_b32 v98, v181, v177, s38
  v_perm_b32 v99, v181, v177, s39
  v_perm_b32 v100, v182, v178, s38
  v_perm_b32 v101, v182, v178, s39
  v_perm_b32 v102, v183, v179, s38
  v_perm_b32 v103, v183, v179, s39
  v_dot2_f32_bf16 v8, v96, v24, 0
  v_dot2_f32_bf16 v9, v97, v24, 0
  v_dot2_f32_bf16 v10, v98, v24, 0
  v_dot2_f32_bf16 v11, v99, v24, 0
  v_dot2_f32_bf16 v12, v100, v24, 0
  v_dot2_f32_bf16 v13, v101, v24, 0
  v_dot2_f32_bf16 v14, v102, v24, 0
  v_dot2_f32_bf16 v15, v103, v24, 0
  s_waitcnt vmcnt(10)
  v_perm_b32 v96, v188, v184, s38
  v_perm_b32 v97, v188, v184, s39
  v_perm_b32 v98, v189, v185, s38
  v_perm_b32 v99, v189, v185, s39
  v_perm_b32 v100, v190, v186, s38
  v_perm_b32 v101, v190, v186, s39
  v_perm_b32 v102, v191, v187, s38
  v_perm_b32 v103, v191, v187, s39
  v_dot2_f32_bf16 v8, v96, v25, v8
  v_dot2_f32_bf16 v9, v97, v25, v9
  v_dot2_f32_bf16 v10, v98, v25, v10
  v_dot2_f32_bf16 v11, v99, v25, v11
  v_dot2_f32_bf16 v12, v100, v25, v12
  v_dot2_f32_bf16 v13, v101, v25, v13
  v_dot2_f32_bf16 v14, v102, v25, v14
  v_dot2_f32_bf16 v15, v103, v25, v15
  s_waitcnt vmcnt(8)
  v_perm_b32 v96, v196, v192, s38
  v_perm_b32 v97, v196, v192, s39
  v_perm_b32 v98, v197, v193, s38
  v_perm_b32 v99, v197, v193, s39
  v_perm_b32 v100, v198, v194, s38
  v_perm_b32 v101, v198, v194, s39
  v_perm_b32 v102, v199, v195, s38
  v_perm_b32 v103, v199, v195, s39
  v_dot2_f32_bf16 v8, v96, v26, v8
  v_dot2_f32_bf16 v9, v97, v26, v9
  v_dot2_f32_bf16 v10, v98, v26, v10
  v_dot2_f32_bf16 v11, v99, v26, v11
  v_dot2_f32_bf16 v12, v100, v26, v12
  v_dot2_f32_bf16 v13, v101, v26, v13
  v_dot2_f32_bf16 v14, v102, v26, v14
  v_dot2_f32_bf16 v15, v103, v26, v15
  s_waitcnt vmcnt(6)
  v_perm_b32 v96, v204, v200, s38
  v_perm_b32 v97, v204, v200, s39
  v_perm_b32 v98, v205, v201, s38
  v_perm_b32 v99, v205, v201, s39
  v_perm_b32 v100, v206, v202, s38
  v_perm_b32 v101, v206, v202, s39
  v_perm_b32 v102, v207, v203, s38
  v_perm_b32 v103, v207, v203, s39
  v_dot2_f32_bf16 v8, v96, v27, v8
  v_dot2_f32_bf16 v9, v97, v27, v9
  v_dot2_f32_bf16 v10, v98, v27, v10
  v_dot2_f32_bf16 v11, v99, v27, v11
  v_dot2_f32_bf16 v12, v100, v27, v12
  v_dot2_f32_bf16 v13, v101, v27, v13
  v_dot2_f32_bf16 v14, v102, v27, v14
  v_dot2_f32_bf16 v15, v103, v27, v15
  s_waitcnt vmcnt(4)
  buffer_load_dword v131, v130, s[56:59], 0 offen sc1
  v_perm_b32 v96, v212, v208, s38
  v_perm_b32 v97, v212, v208, s39
  v_perm_b32 v98, v213, v209, s38
  v_perm_b32 v99, v213, v209, s39
  v_perm_b32 v100, v214, v210, s38
  v_perm_b32 v101, v214, v210, s39
  v_perm_b32 v102, v215, v211, s38
  v_perm_b32 v103, v215, v211, s39
  v_dot2_f32_bf16 v8, v96, v28, v8
  v_dot2_f32_bf16 v9, v97, v28, v9
  v_dot2_f32_bf16 v10, v98, v28, v10
  v_dot2_f32_bf16 v11, v99, v28, v11
  v_dot2_f32_bf16 v12, v100, v28, v12
  v_dot2_f32_bf16 v13, v101, v28, v13
  v_dot2_f32_bf16 v14, v102, v28, v14
  v_dot2_f32_bf16 v15, v103, v28, v15
  s_waitcnt vmcnt(3)
  v_perm_b32 v96, v220, v216, s38
  v_perm_b32 v97, v220, v216, s39
  v_perm_b32 v98, v221, v217, s38
  v_perm_b32 v99, v221, v217, s39
  v_perm_b32 v100, v222, v218, s38
  v_perm_b32 v101, v222, v218, s39
  v_perm_b32 v102, v223, v219, s38
  v_perm_b32 v103, v223, v219, s39
  v_dot2_f32_bf16 v8, v96, v29, v8
  v_dot2_f32_bf16 v9, v97, v29, v9
  v_dot2_f32_bf16 v10, v98, v29, v10
  v_dot2_f32_bf16 v11, v99, v29, v11
  v_dot2_f32_bf16 v12, v100, v29, v12
  v_dot2_f32_bf16 v13, v101, v29, v13
  v_dot2_f32_bf16 v14, v102, v29, v14
  v_dot2_f32_bf16 v15, v103, v29, v15
  s_waitcnt vmcnt(1)
  v_perm_b32 v96, v228, v224, s38
  v_perm_b32 v97, v228, v224, s39
  v_perm_b32 v98, v229, v225, s38
  v_perm_b32 v99, v229, v225, s39
  v_perm_b32 v100, v230, v226, s38
  v_perm_b32 v101, v230, v226, s39
  v_perm_b32 v102, v231, v227, s38
  v_perm_b32 v103, v231, v227, s39
  v_dot2_f32_bf16 v8, v96, v30, v8
  v_dot2_f32_bf16 v9, v97, v30, v9
  v_dot2_f32_bf16 v10, v98, v30, v10
  v_dot2_f32_bf16 v11, v99, v30, v11
  v_dot2_f32_bf16 v12, v100, v30, v12
  v_dot2_f32_bf16 v13, v101, v30, v13
  v_dot2_f32_bf16 v14, v102, v30, v14
  v_dot2_f32_bf16 v15, v103, v30, v15
  v_permlane32_swap_b32 v8, v12
  v_permlane32_swap_b32 v9, v13
  v_permlane32_swap_b32 v10, v14
  v_permlane32_swap_b32 v11, v15
  v_add_f32 v8, v8, v12
  v_add_f32 v9, v9, v13
  v_add_f32 v10, v10, v14
  v_add_f32 v11, v11, v15
  s_nop 0
  v_permlane16_swap_b32 v8, v10
  v_permlane16_swap_b32 v9, v11
  v_add_f32 v8, v8, v10
  v_add_f32 v9, v9, v11
  v_lshlrev_b32 v5, 5, v3
  v_and_b32 v6, 3, v4
  v_lshl_add_u32 v5, v6, 3, v5
  v_lshl_add_u32 v5, v2, 9, v5
  ds_write_b64 v5, v[8:9]
  v_lshlrev_b32 v10, 2, v0
  s_lshl_b32 s40, s100, 9
  s_add_u32 s40, s40, 12902400
  s_waitcnt lgkmcnt(0)
  s_barrier
  s_cmp_ge_u32 s87, 2
  s_cbranch_scc1 K1_MD2
  ds_read_b32 v32, v10 offset:0
  ds_read_b32 v33, v10 offset:512
  ds_read_b32 v34, v10 offset:1024
  ds_read_b32 v35, v10 offset:1536
  ds_read_b32 v36, v10 offset:2048
  ds_read_b32 v37, v10 offset:2560
  ds_read_b32 v38, v10 offset:3072
  ds_read_b32 v39, v10 offset:3584
  s_waitcnt lgkmcnt(0)
  v_add_f32 v32, v32, v36
  v_add_f32 v33, v33, v37
  v_add_f32 v34, v34, v38
  v_add_f32 v35, v35, v39
  v_add_f32 v32, v32, v34
  v_add_f32 v33, v33, v35
  v_add_f32 v32, v32, v33
  v_or_b32 v31, 1, v32
  s_waitcnt vmcnt(0)
  buffer_store_dword v31, v10, s[28:31], s40 offen sc1
  v_cmp_ne_u32 vcc, -1, v131
  s_and_b32 s61, vcc_lo, 768
  s_nop 3
  s_cbranch_scc0 K1_P9M
  s_movk_i32 s63, 3000
K1_S1M:
  v_cmp_ne_u32 vcc, -1, v131
  s_and_b32 s61, vcc_lo, 768
  s_nop 3
  s_cbranch_scc0 K1_S2M
  s_sub_u32 s63, s63, 1
  s_cbranch_scc1 K1_S2M
  s_sleep 4
  buffer_load_dword v131, v130, s[56:59], 0 offen sc1
  s_waitcnt vmcnt(0)
  s_branch K1_S1M
K1_S2M:
  buffer_store_dword v31, v10, s[28:31], s40 offen sc1
K1_P9M:
K1_MD2:
  s_barrier
  s_cmp_eq_u32 s100, 20
  s_cbranch_scc1 K1_END
  s_cmp_ge_u32 s100, 18
  s_cbranch_scc1 K1_ST
  s_add_u32 s100, s100, 2
  s_cmp_ge_u32 s3, 16
  s_cbranch_scc1 K1_MOD
  s_mul_i32 s6, s3, 458752
  s_add_u32 s6, s6, 5505024
  v_mov_b32 v8, -1
  v_mov_b32 v9, -1
  v_mov_b32 v10, -1
  v_mov_b32 v11, -1
  v_lshlrev_b32 v4, 4, v0
  s_movk_i32 s7, 27
  s_nop 0
K1_SFA:
  buffer_store_dwordx4 v[8:11], v4, s[28:31], s6 offen sc1
  s_add_u32 s6, s6, 8192
  s_sub_u32 s7, s7, 1
  s_cbranch_scc0 K1_SFA
  s_branch K1_ST
K1_CS:
  s_sub_u32 s5, s3, 18
  s_bitcmp1_b32 s87, 0
  s_waitcnt lgkmcnt(0)
  s_cselect_b32 s80, s50, s48
  s_cselect_b32 s81, s51, s49
  v_lshrrev_b32 v17, 4, v1
  s_and_b32 s85, s87, 1
  s_lshl_b32 s86, s85, 2
  v_or_b32 v140, s86, v17
  v_lshlrev_b32 v140, 5, v140
  v_and_b32 v18, 15, v1
  v_lshlrev_b32 v18, 4, v18
  v_xor_b32 v140, v140, v18
  v_mul_u32_u24 v18, 3584, v17
  v_add_u32 v140, v140, v18
  s_lshl_b32 s86, s85, 13
  s_lshr_b32 s85, s87, 1
  s_mul_i32 s84, s85, 28672
  s_lshl_b32 s85, s85, 11
  s_add_u32 s86, s86, s85
  s_lshl_b32 s85, s5, 8
  s_add_u32 s84, s84, s85
  v_and_b32 v17, 1, v17
  v_bfe_u32 v18, v1, 2, 2
  v_lshrrev_b32 v141, 5, v1
  v_lshl_add_u32 v141, v141, 3, v18
  v_lshlrev_b32 v141, 8, v141
  v_lshl_add_u32 v141, v17, 13, v141
  v_lshl_or_b32 v17, v17, 2, v18
  v_xor_b32 v17, s87, v17
  v_lshl_add_u32 v141, v17, 5, v141
  v_and_b32 v17, 1, v1
  v_lshl_add_u32 v141, v17, 4, v141
  v_and_b32 v17, 2, v1
  v_lshl_add_u32 v141, v17, 2, v141
  v_add_u32 v141, 0, v141
  v_add_u32 v142, 49152, v141
  v_and_b32 v17, 7, v1
  v_min_u32 v17, 5, v17
  v_lshlrev_b32 v17, 7, v17
  v_bfe_u32 v16, v1, 3, 2
  v_mul_u32_u24 v16, 5376, v16
  s_lshl_b32 s60, s5, 3
  s_add_u32 s60, s60, s87
  s_mul_i32 s60, s60, 21504
  s_add_u32 s60, s60, 4608
  v_add3_u32 v17, v17, v16, s60
  global_load_dword v16, v17, s[96:97]
  s_add_u32 m0, s86, 0
  s_add_u32 s85, s84, 0
  buffer_load_dwordx4 v140, s[80:83], s85 offen lds
  s_add_u32 s85, s85, 13312
  buffer_load_dwordx4 v140, s[80:83], s85 offen offset:1024 lds
  s_add_u32 m0, s86, 16384
  s_add_u32 s85, s84, 114688
  buffer_load_dwordx4 v140, s[80:83], s85 offen lds
  s_add_u32 s85, s85, 13312
  buffer_load_dwordx4 v140, s[80:83], s85 offen offset:1024 lds
  s_add_u32 m0, s86, 32768
  s_add_u32 s85, s84, 229376
  buffer_load_dwordx4 v140, s[80:83], s85 offen lds
  s_add_u32 s85, s85, 13312
  buffer_load_dwordx4 v140, s[80:83], s85 offen offset:1024 lds
  s_add_u32 m0, s86, 49152
  s_add_u32 s85, s84, 344064
  buffer_load_dwordx4 v140, s[80:83], s85 offen lds
  s_add_u32 s85, s85, 13312
  buffer_load_dwordx4 v140, s[80:83], s85 offen offset:1024 lds
  s_add_u32 m0, s86, 65536
  s_add_u32 s85, s84, 458752
  buffer_load_dwordx4 v140, s[80:83], s85 offen lds
  s_add_u32 s85, s85, 13312
  buffer_load_dwordx4 v140, s[80:83], s85 offen offset:1024 lds
  s_add_u32 m0, s86, 81920
  s_add_u32 s85, s84, 573440
  buffer_load_dwordx4 v140, s[80:83], s85 offen lds
  s_add_u32 s85, s85, 13312
  buffer_load_dwordx4 v140, s[80:83], s85 offen offset:1024 lds
  v_min_u32 v25, 447, v0
  v_lshlrev_b32 v26, 2, v25
  v_lshlrev_b32 v25, 1, v25
  v_add_u32 v25, 98304, v25
  v_and_b32 v27, 1, v0
  v_mul_u32_u24 v27, 896, v27
  v_lshrrev_b32 v17, 5, v1
  v_lshl_add_u32 v27, v17, 4, v27
  v_add_u32 v27, 98304, v27
  s_mov_b32 s45, 12907776
  s_lshl_b32 s46, s5, 3
  s_add_u32 s46, s46, s87
  s_lshl_b32 s46, s46, 8
  s_add_u32 s46, s46, 12935168
  s_waitcnt vmcnt(8) lgkmcnt(0)
  s_barrier
  ds_read_b64_tr_b16 v[168:169], v141 offset:0
  ds_read_b64_tr_b16 v[170:171], v141 offset:1024
  ds_read_b64_tr_b16 v[172:173], v141 offset:4096
  ds_read_b64_tr_b16 v[174:175], v141 offset:5120
  ds_read_b64_tr_b16 v[176:177], v141 offset:16384
  ds_read_b64_tr_b16 v[178:179], v141 offset:17408
  ds_read_b64_tr_b16 v[180:181], v141 offset:20480
  ds_read_b64_tr_b16 v[182:183], v141 offset:21504
  s_waitcnt vmcnt(4) lgkmcnt(0)
  s_barrier
  ds_read_b64_tr_b16 v[184:185], v141 offset:32768
  ds_read_b64_tr_b16 v[186:187], v141 offset:33792
  ds_read_b64_tr_b16 v[188:189], v141 offset:36864
  ds_read_b64_tr_b16 v[190:191], v141 offset:37888
  ds_read_b64_tr_b16 v[192:193], v142 offset:0
  ds_read_b64_tr_b16 v[194:195], v142 offset:1024
  ds_read_b64_tr_b16 v[196:197], v142 offset:4096
  ds_read_b64_tr_b16 v[198:199], v142 offset:5120
  buffer_load_dword v131, v130, s[56:59], 0 offen sc1
  s_add_u32 m0, s86, 0
  s_add_u32 s85, s84, 688128
  buffer_load_dwordx4 v140, s[80:83], s85 offen lds
  s_add_u32 s85, s85, 13312
  buffer_load_dwordx4 v140, s[80:83], s85 offen offset:1024 lds
  s_add_u32 m0, s86, 16384
  s_add_u32 s85, s84, 802816
  buffer_load_dwordx4 v140, s[80:83], s85 offen lds
  s_add_u32 s85, s85, 13312
  buffer_load_dwordx4 v140, s[80:83], s85 offen offset:1024 lds
  s_waitcnt vmcnt(4) lgkmcnt(0)
  s_barrier
  ds_read_b64_tr_b16 v[200:201], v142 offset:16384
  ds_read_b64_tr_b16 v[202:203], v142 offset:17408
  ds_read_b64_tr_b16 v[204:205], v142 offset:20480
  ds_read_b64_tr_b16 v[206:207], v142 offset:21504
  ds_read_b64_tr_b16 v[208:209], v142 offset:32768
  ds_read_b64_tr_b16 v[210:211], v142 offset:33792
  ds_read_b64_tr_b16 v[212:213], v142 offset:36864
  ds_read_b64_tr_b16 v[214:215], v142 offset:37888
  s_add_u32 m0, s86, 32768
  s_add_u32 s85, s84, 917504
  buffer_load_dwordx4 v140, s[80:83], s85 offen lds
  s_add_u32 s85, s85, 13312
  buffer_load_dwordx4 v140, s[80:83], s85 offen offset:1024 lds
  s_add_u32 m0, s86, 49152
  s_add_u32 s85, s84, 1032192
  buffer_load_dwordx4 v140, s[80:83], s85 offen lds
  s_add_u32 s85, s85, 13312
  buffer_load_dwordx4 v140, s[80:83], s85 offen offset:1024 lds
  s_waitcnt vmcnt(4) lgkmcnt(0)
  s_barrier
  ds_read_b64_tr_b16 v[216:217], v141 offset:0
  ds_read_b64_tr_b16 v[218:219], v141 offset:1024
  ds_read_b64_tr_b16 v[220:221], v141 offset:4096
  ds_read_b64_tr_b16 v[222:223], v141 offset:5120
  ds_read_b64_tr_b16 v[224:225], v141 offset:16384
  ds_read_b64_tr_b16 v[226:227], v141 offset:17408
  ds_read_b64_tr_b16 v[228:229], v141 offset:20480
  ds_read_b64_tr_b16 v[230:231], v141 offset:21504
  s_movk_i32 s63, 3000
K1_S1C:
  v_cmp_ne_u32 vcc, -1, v131
  s_and_b32 s61, vcc_lo, 3967
  s_nop 3
  s_cbranch_scc0 K1_S2C
  s_sub_u32 s63, s63, 1
  s_cbranch_scc1 K1_S2C
  s_sleep 4
  buffer_load_dword v131, v130, s[56:59], 0 offen sc1
  s_waitcnt vmcnt(0)
  s_branch K1_S1C
K1_S2C:
  buffer_load_dword v32, v26, s[28:31], s45 offen sc1
  buffer_load_dword v33, v26, s[28:31], s45 offen offset:1792 sc1
  s_add_u32 m0, s86, 65536
  s_add_u32 s85, s84, 1146880
  buffer_load_dwordx4 v140, s[80:83], s85 offen lds
  s_add_u32 s85, s85, 13312
  buffer_load_dwordx4 v140, s[80:83], s85 offen offset:1024 lds
  s_add_u32 m0, s86, 81920
  s_add_u32 s85, s84, 1261568
  buffer_load_dwordx4 v140, s[80:83], s85 offen lds
  s_add_u32 s85, s85, 13312
  buffer_load_dwordx4 v140, s[80:83], s85 offen offset:1024 lds
  s_waitcnt vmcnt(4) lgkmcnt(0)
  s_barrier
  ds_read_b64_tr_b16 v[232:233], v141 offset:32768
  ds_read_b64_tr_b16 v[234:235], v141 offset:33792
  ds_read_b64_tr_b16 v[236:237], v141 offset:36864
  ds_read_b64_tr_b16 v[238:239], v141 offset:37888
  ds_read_b64_tr_b16 v[144:145], v142 offset:0
  ds_read_b64_tr_b16 v[146:147], v142 offset:1024
  ds_read_b64_tr_b16 v[148:149], v142 offset:4096
  ds_read_b64_tr_b16 v[150:151], v142 offset:5120
  s_add_u32 m0, s86, 0
  s_add_u32 s85, s84, 1376256
  buffer_load_dwordx4 v140, s[80:83], s85 offen lds
  s_add_u32 s85, s85, 13312
  buffer_load_dwordx4 v140, s[80:83], s85 offen offset:1024 lds
  s_add_u32 m0, s86, 16384
  s_add_u32 s85, s84, 1490944
  buffer_load_dwordx4 v140, s[80:83], s85 offen lds
  s_add_u32 s85, s85, 13312
  buffer_load_dwordx4 v140, s[80:83], s85 offen offset:1024 lds
  s_movk_i32 s63, 3000
K1_CP:
  v_and_b32 v34, v32, v33
  v_and_b32 v34, 1, v34
  v_cmp_ne_u32 vcc, 1, v34
  s_nop 4
  s_cbranch_vccz K1_CQ
  s_sub_u32 s63, s63, 1
  s_sleep 8
  buffer_load_dword v32, v26, s[28:31], s45 offen sc1
  buffer_load_dword v33, v26, s[28:31], s45 offen offset:1792 sc1
  s_waitcnt vmcnt(0)
  s_cbranch_scc0 K1_CP
K1_CQ:
  v_cvt_pk_bf16_f32 v32, v32, v33
  v_and_b32 v33, s55, v32
  v_add_f32 v33, 1.0, v33
  v_cvt_pk_bf16_f32 v33, v33, v33
  ds_write_b16 v25, v33
  ds_write_b16 v25, v32 offset:896
  s_waitcnt vmcnt(4) lgkmcnt(0)
  s_barrier
  ds_read_b64_tr_b16 v[152:153], v142 offset:16384
  ds_read_b64_tr_b16 v[154:155], v142 offset:17408
  ds_read_b64_tr_b16 v[156:157], v142 offset:20480
  ds_read_b64_tr_b16 v[158:159], v142 offset:21504
  ds_read_b64_tr_b16 v[160:161], v142 offset:32768
  ds_read_b64_tr_b16 v[162:163], v142 offset:33792
  ds_read_b64_tr_b16 v[164:165], v142 offset:36864
  ds_read_b64_tr_b16 v[166:167], v142 offset:37888
  ds_read_b128 v[48:51], v27 offset:0
  ds_read_b128 v[52:55], v27 offset:32
  ds_read_b128 v[56:59], v27 offset:64
  ds_read_b128 v[60:63], v27 offset:96
  ds_read_b128 v[64:67], v27 offset:128
  ds_read_b128 v[68:71], v27 offset:160
  ds_read_b128 v[72:75], v27 offset:192
  ds_read_b128 v[76:79], v27 offset:224
  ds_read_b128 v[80:83], v27 offset:256
  ds_read_b128 v[84:87], v27 offset:288
  ds_read_b128 v[88:91], v27 offset:320
  ds_read_b128 v[92:95], v27 offset:352
  ds_read_b128 v[96:99], v27 offset:384
  ds_read_b128 v[100:103], v27 offset:416
  s_waitcnt lgkmcnt(13)
  v_mfma_f32_32x32x16_bf16 v[32:47], v[48:51], v[168:171], 0
  s_waitcnt lgkmcnt(12)
  v_mfma_f32_32x32x16_bf16 v[32:47], v[52:55], v[172:175], v[32:47]
  s_waitcnt lgkmcnt(11)
  v_mfma_f32_32x32x16_bf16 v[32:47], v[56:59], v[176:179], v[32:47]
  s_waitcnt lgkmcnt(10)
  v_mfma_f32_32x32x16_bf16 v[32:47], v[60:63], v[180:183], v[32:47]
  s_waitcnt lgkmcnt(9)
  v_mfma_f32_32x32x16_bf16 v[32:47], v[64:67], v[184:187], v[32:47]
  s_waitcnt lgkmcnt(8)
  v_mfma_f32_32x32x16_bf16 v[32:47], v[68:71], v[188:191], v[32:47]
  s_waitcnt lgkmcnt(7)
  v_mfma_f32_32x32x16_bf16 v[32:47], v[72:75], v[192:195], v[32:47]
  s_waitcnt lgkmcnt(6)
  v_mfma_f32_32x32x16_bf16 v[32:47], v[76:79], v[196:199], v[32:47]
  s_waitcnt lgkmcnt(5)
  v_mfma_f32_32x32x16_bf16 v[32:47], v[80:83], v[200:203], v[32:47]
  s_waitcnt lgkmcnt(4)
  v_mfma_f32_32x32x16_bf16 v[32:47], v[84:87], v[204:207], v[32:47]
  s_waitcnt lgkmcnt(3)
  v_mfma_f32_32x32x16_bf16 v[32:47], v[88:91], v[208:211], v[32:47]
  s_waitcnt lgkmcnt(2)
  v_mfma_f32_32x32x16_bf16 v[32:47], v[92:95], v[212:215], v[32:47]
  s_waitcnt lgkmcnt(1)
  v_mfma_f32_32x32x16_bf16 v[32:47], v[96:99], v[216:219], v[32:47]
  s_waitcnt lgkmcnt(0)
  v_mfma_f32_32x32x16_bf16 v[32:47], v[100:103], v[220:223], v[32:47]
  s_nop 7
  ds_read_b128 v[48:51], v27 offset:448
  ds_read_b128 v[52:55], v27 offset:480
  ds_read_b128 v[56:59], v27 offset:512
  ds_read_b128 v[60:63], v27 offset:544
  ds_read_b128 v[64:67], v27 offset:576
  ds_read_b128 v[68:71], v27 offset:608
  ds_read_b128 v[72:75], v27 offset:640
  ds_read_b128 v[76:79], v27 offset:672
  ds_read_b128 v[80:83], v27 offset:704
  ds_read_b128 v[84:87], v27 offset:736
  s_waitcnt lgkmcnt(9)
  v_mfma_f32_32x32x16_bf16 v[32:47], v[48:51], v[224:227], v[32:47]
  s_waitcnt lgkmcnt(8)
  v_mfma_f32_32x32x16_bf16 v[32:47], v[52:55], v[228:231], v[32:47]
  s_waitcnt lgkmcnt(7)
  v_mfma_f32_32x32x16_bf16 v[32:47], v[56:59], v[232:235], v[32:47]
  s_waitcnt lgkmcnt(6)
  v_mfma_f32_32x32x16_bf16 v[32:47], v[60:63], v[236:239], v[32:47]
  s_waitcnt lgkmcnt(5)
  v_mfma_f32_32x32x16_bf16 v[32:47], v[64:67], v[144:147], v[32:47]
  s_waitcnt lgkmcnt(4)
  v_mfma_f32_32x32x16_bf16 v[32:47], v[68:71], v[148:151], v[32:47]
  s_waitcnt lgkmcnt(3)
  v_mfma_f32_32x32x16_bf16 v[32:47], v[72:75], v[152:155], v[32:47]
  s_waitcnt lgkmcnt(2)
  v_mfma_f32_32x32x16_bf16 v[32:47], v[76:79], v[156:159], v[32:47]
  s_waitcnt lgkmcnt(1)
  v_mfma_f32_32x32x16_bf16 v[32:47], v[80:83], v[160:163], v[32:47]
  s_waitcnt lgkmcnt(0)
  v_mfma_f32_32x32x16_bf16 v[32:47], v[84:87], v[164:167], v[32:47]
  s_nop 7
  s_waitcnt vmcnt(0) lgkmcnt(0)
  s_barrier
  ds_read_b64_tr_b16 v[240:241], v141 offset:0
  ds_read_b64_tr_b16 v[242:243], v141 offset:1024
  ds_read_b64_tr_b16 v[244:245], v141 offset:4096
  ds_read_b64_tr_b16 v[246:247], v141 offset:5120
  ds_read_b64_tr_b16 v[248:249], v141 offset:16384
  ds_read_b64_tr_b16 v[250:251], v141 offset:17408
  ds_read_b64_tr_b16 v[252:253], v141 offset:20480
  ds_read_b64_tr_b16 v[254:255], v141 offset:21504
  ds_read_b128 v[88:91], v27 offset:768
  ds_read_b128 v[92:95], v27 offset:800
  ds_read_b128 v[96:99], v27 offset:832
  ds_read_b128 v[100:103], v27 offset:864
  s_waitcnt lgkmcnt(3)
  v_mfma_f32_32x32x16_bf16 v[32:47], v[88:91], v[240:243], v[32:47]
  s_waitcnt lgkmcnt(2)
  v_mfma_f32_32x32x16_bf16 v[32:47], v[92:95], v[244:247], v[32:47]
  s_waitcnt lgkmcnt(1)
  v_mfma_f32_32x32x16_bf16 v[32:47], v[96:99], v[248:251], v[32:47]
  s_waitcnt lgkmcnt(0)
  v_mfma_f32_32x32x16_bf16 v[32:47], v[100:103], v[252:255], v[32:47]
  s_nop 7
  s_nop 3
  v_cvt_pk_bf16_f32 v12, v32, v33
  v_lshlrev_b32 v13, 16, v12
  v_and_b32 v17, s55, v12
  v_sub_f32 v32, v32, v13
  v_sub_f32 v33, v33, v17
  v_cvt_pk_bf16_f32 v12, v13, v32
  v_cvt_pk_bf16_f32 v13, v17, v33
  v_or_b32 v12, 0x10000, v12
  v_lshlrev_b32 v14, 3, v1
  s_mov_b32 exec_hi, 0
  buffer_store_dwordx2 v[12:13], v14, s[28:31], s46 offen sc1
  s_mov_b32 exec_hi, -1
K1_ST:
  s_setprio 0
  s_and_b32 s5, s3, 15
  s_lshl_b32 s5, s5, 1
  s_lshr_b32 s9, s3, 4
  s_add_u32 s5, s5, s9
  s_mul_i32 s9, s5, 57344
  s_mul_i32 s10, s87, 7168
  s_add_u32 s9, s9, s10
  s_add_u32 s9, s9, 1835008
  s_add_u32 s10, s9, 4096
  v_lshlrev_b32 v5, 4, v1
  v_min_u32 v7, 27, v1
  v_lshlrev_b32 v7, 6, v7
  s_and_b32 s11, s3, 7
  s_lshl_b32 s11, s11, 3
  s_add_u32 s11, s11, s87
  s_mul_i32 s11, s11, 1792
  s_add_u32 s11, s11, 12967936
  s_lshl_b32 s12, s3, 7
  s_add_u32 s12, s12, 12926976
  s_cmp_lg_u32 s87, 0
  s_cbranch_scc1 K1_SM
  s_movk_i32 s63, 3000
K1_S1T:
  v_cmp_ne_u32 vcc, -1, v131
  s_and_b32 s61, vcc_lo, 3967
  s_nop 3
  s_cbranch_scc0 K1_S2T
  s_sub_u32 s63, s63, 1
  s_cbranch_scc1 K1_S2T
  s_sleep 4
  buffer_load_dword v131, v130, s[56:59], 0 offen sc1
  s_waitcnt vmcnt(0)
  s_branch K1_S1T
K1_S2T:
  s_movk_i32 s63, 3000
K1_SN:
  buffer_load_dword v8, off, s[28:31], s12 sc1
  s_waitcnt vmcnt(0)
  v_cmp_eq_u32 vcc, 0, v8
  s_nop 4
  s_cbranch_vccz K1_SM
  s_sub_u32 s63, s63, 1
  s_sleep 4
  s_cbranch_scc0 K1_SN
K1_SM:
  s_barrier
  s_movk_i32 s63, 3000
K1_SP:
  buffer_load_dword v8, v7, s[28:31], s11 offen sc1
  s_waitcnt vmcnt(0)
  v_cmp_eq_u32 vcc, 0, v8
  s_nop 4
  s_cbranch_vccz K1_SW
  s_sub_u32 s63, s63, 1
  s_sleep 4
  s_cbranch_scc0 K1_SP
K1_SW:
  s_movk_i32 s63, 3000
K1_SL:
  buffer_load_dwordx4 v[32:35], v5, s[28:31], s9 offen offset:0 sc1
  buffer_load_dwordx4 v[36:39], v5, s[28:31], s9 offen offset:1024 sc1
  buffer_load_dwordx4 v[40:43], v5, s[28:31], s9 offen offset:2048 sc1
  buffer_load_dwordx4 v[44:47], v5, s[28:31], s9 offen offset:3072 sc1
  buffer_load_dwordx4 v[48:51], v5, s[28:31], s10 offen offset:0 sc1
  buffer_load_dwordx4 v[52:55], v5, s[28:31], s10 offen offset:1024 sc1
  buffer_load_dwordx4 v[56:59], v5, s[28:31], s10 offen offset:2048 sc1
  s_waitcnt vmcnt(6)
  v_max3_u32 v8, v32, v34, 0
  v_lshlrev_b32 v64, 16, v32
  v_and_b32 v65, s55, v32
  v_lshlrev_b32 v66, 16, v33
  v_and_b32 v67, s55, v33
  v_lshlrev_b32 v68, 16, v34
  v_and_b32 v69, s55, v34
  v_lshlrev_b32 v70, 16, v35
  v_and_b32 v71, s55, v35
  v_pk_mul_f32 v[72:73], v[64:65], v[64:65]
  v_pk_mul_f32 v[74:75], v[66:67], v[66:67]
  v_pk_mul_f32 v[76:77], v[68:69], v[68:69]
  v_pk_mul_f32 v[78:79], v[70:71], v[70:71]
  s_waitcnt vmcnt(5)
  v_max3_u32 v8, v36, v38, v8
  v_lshlrev_b32 v80, 16, v36
  v_and_b32 v81, s55, v36
  v_lshlrev_b32 v82, 16, v37
  v_and_b32 v83, s55, v37
  v_lshlrev_b32 v84, 16, v38
  v_and_b32 v85, s55, v38
  v_lshlrev_b32 v86, 16, v39
  v_and_b32 v87, s55, v39
  v_pk_fma_f32 v[72:73], v[80:81], v[80:81], v[72:73]
  v_pk_add_f32 v[64:65], v[64:65], v[80:81]
  v_pk_fma_f32 v[74:75], v[82:83], v[82:83], v[74:75]
  v_pk_add_f32 v[66:67], v[66:67], v[82:83]
  v_pk_fma_f32 v[76:77], v[84:85], v[84:85], v[76:77]
  v_pk_add_f32 v[68:69], v[68:69], v[84:85]
  v_pk_fma_f32 v[78:79], v[86:87], v[86:87], v[78:79]
  v_pk_add_f32 v[70:71], v[70:71], v[86:87]
  s_waitcnt vmcnt(4)
  v_max3_u32 v8, v40, v42, v8
  v_lshlrev_b32 v80, 16, v40
  v_and_b32 v81, s55, v40
  v_lshlrev_b32 v82, 16, v41
  v_and_b32 v83, s55, v41
  v_lshlrev_b32 v84, 16, v42
  v_and_b32 v85, s55, v42
  v_lshlrev_b32 v86, 16, v43
  v_and_b32 v87, s55, v43
  v_pk_fma_f32 v[72:73], v[80:81], v[80:81], v[72:73]
  v_pk_add_f32 v[64:65], v[64:65], v[80:81]
  v_pk_fma_f32 v[74:75], v[82:83], v[82:83], v[74:75]
  v_pk_add_f32 v[66:67], v[66:67], v[82:83]
  v_pk_fma_f32 v[76:77], v[84:85], v[84:85], v[76:77]
  v_pk_add_f32 v[68:69], v[68:69], v[84:85]
  v_pk_fma_f32 v[78:79], v[86:87], v[86:87], v[78:79]
  v_pk_add_f32 v[70:71], v[70:71], v[86:87]
  s_waitcnt vmcnt(3)
  v_max3_u32 v8, v44, v46, v8
  v_lshlrev_b32 v80, 16, v44
  v_and_b32 v81, s55, v44
  v_lshlrev_b32 v82, 16, v45
  v_and_b32 v83, s55, v45
  v_lshlrev_b32 v84, 16, v46
  v_and_b32 v85, s55, v46
  v_lshlrev_b32 v86, 16, v47
  v_and_b32 v87, s55, v47
  v_pk_fma_f32 v[72:73], v[80:81], v[80:81], v[72:73]
  v_pk_add_f32 v[64:65], v[64:65], v[80:81]
  v_pk_fma_f32 v[74:75], v[82:83], v[82:83], v[74:75]
  v_pk_add_f32 v[66:67], v[66:67], v[82:83]
  v_pk_fma_f32 v[76:77], v[84:85], v[84:85], v[76:77]
  v_pk_add_f32 v[68:69], v[68:69], v[84:85]
  v_pk_fma_f32 v[78:79], v[86:87], v[86:87], v[78:79]
  v_pk_add_f32 v[70:71], v[70:71], v[86:87]
  s_waitcnt vmcnt(2)
  v_max3_u32 v8, v48, v50, v8
  v_lshlrev_b32 v80, 16, v48
  v_and_b32 v81, s55, v48
  v_lshlrev_b32 v82, 16, v49
  v_and_b32 v83, s55, v49
  v_lshlrev_b32 v84, 16, v50
  v_and_b32 v85, s55, v50
  v_lshlrev_b32 v86, 16, v51
  v_and_b32 v87, s55, v51
  v_pk_fma_f32 v[72:73], v[80:81], v[80:81], v[72:73]
  v_pk_add_f32 v[64:65], v[64:65], v[80:81]
  v_pk_fma_f32 v[74:75], v[82:83], v[82:83], v[74:75]
  v_pk_add_f32 v[66:67], v[66:67], v[82:83]
  v_pk_fma_f32 v[76:77], v[84:85], v[84:85], v[76:77]
  v_pk_add_f32 v[68:69], v[68:69], v[84:85]
  v_pk_fma_f32 v[78:79], v[86:87], v[86:87], v[78:79]
  v_pk_add_f32 v[70:71], v[70:71], v[86:87]
  s_waitcnt vmcnt(1)
  v_max3_u32 v8, v52, v54, v8
  v_lshlrev_b32 v80, 16, v52
  v_and_b32 v81, s55, v52
  v_lshlrev_b32 v82, 16, v53
  v_and_b32 v83, s55, v53
  v_lshlrev_b32 v84, 16, v54
  v_and_b32 v85, s55, v54
  v_lshlrev_b32 v86, 16, v55
  v_and_b32 v87, s55, v55
  v_pk_fma_f32 v[72:73], v[80:81], v[80:81], v[72:73]
  v_pk_add_f32 v[64:65], v[64:65], v[80:81]
  v_pk_fma_f32 v[74:75], v[82:83], v[82:83], v[74:75]
  v_pk_add_f32 v[66:67], v[66:67], v[82:83]
  v_pk_fma_f32 v[76:77], v[84:85], v[84:85], v[76:77]
  v_pk_add_f32 v[68:69], v[68:69], v[84:85]
  v_pk_fma_f32 v[78:79], v[86:87], v[86:87], v[78:79]
  v_pk_add_f32 v[70:71], v[70:71], v[86:87]
  s_waitcnt vmcnt(0)
  v_max3_u32 v8, v56, v58, v8
  v_lshlrev_b32 v80, 16, v56
  v_and_b32 v81, s55, v56
  v_lshlrev_b32 v82, 16, v57
  v_and_b32 v83, s55, v57
  v_lshlrev_b32 v84, 16, v58
  v_and_b32 v85, s55, v58
  v_lshlrev_b32 v86, 16, v59
  v_and_b32 v87, s55, v59
  v_pk_fma_f32 v[72:73], v[80:81], v[80:81], v[72:73]
  v_pk_add_f32 v[64:65], v[64:65], v[80:81]
  v_pk_fma_f32 v[74:75], v[82:83], v[82:83], v[74:75]
  v_pk_add_f32 v[66:67], v[66:67], v[82:83]
  v_pk_fma_f32 v[76:77], v[84:85], v[84:85], v[76:77]
  v_pk_add_f32 v[68:69], v[68:69], v[84:85]
  v_pk_fma_f32 v[78:79], v[86:87], v[86:87], v[78:79]
  v_pk_add_f32 v[70:71], v[70:71], v[86:87]
  v_cmp_eq_u32 vcc, -1, v8
  s_nop 4
  s_cbranch_vccz K1_SG
  s_sub_u32 s63, s63, 1
  s_cbranch_scc0 K1_SL
K1_SG:
  v_permlane32_swap_b32 v64, v72
  v_permlane32_swap_b32 v65, v73
  v_permlane32_swap_b32 v66, v74
  v_permlane32_swap_b32 v67, v75
  v_permlane32_swap_b32 v68, v76
  v_permlane32_swap_b32 v69, v77
  v_permlane32_swap_b32 v70, v78
  v_permlane32_swap_b32 v71, v79
  v_add_f32 v64, v64, v72
  v_add_f32 v65, v65, v73
  v_add_f32 v66, v66, v74
  v_add_f32 v67, v67, v75
  v_add_f32 v68, v68, v76
  v_add_f32 v69, v69, v77
  v_add_f32 v70, v70, v78
  v_add_f32 v71, v71, v79
  v_permlane16_swap_b32 v64, v68
  v_permlane16_swap_b32 v65, v69
  v_permlane16_swap_b32 v66, v70
  v_permlane16_swap_b32 v67, v71
  v_add_f32 v64, v64, v68
  v_add_f32 v65, v65, v69
  v_add_f32 v66, v66, v70
  v_add_f32 v67, v67, v71
  v_add_f32_dpp v64, v64, v64 row_ror:8 row_mask:0xf bank_mask:0xf
  v_add_f32_dpp v65, v65, v65 row_ror:8 row_mask:0xf bank_mask:0xf
  v_add_f32_dpp v66, v66, v66 row_ror:8 row_mask:0xf bank_mask:0xf
  v_add_f32_dpp v67, v67, v67 row_ror:8 row_mask:0xf bank_mask:0xf
  v_and_b32 v3, 7, v0
  v_lshlrev_b32 v3, 5, v3
  v_and_b32 v4, 16, v0
  v_add_u32 v3, v3, v4
  v_lshrrev_b32 v4, 5, v0
  v_lshl_add_u32 v3, v4, 8, v3
  ds_write_b128 v3, v[64:67]
  v_lshlrev_b32 v4, 2, v1
  s_lshl_b32 s9, s5, 8
  s_add_u32 s9, s9, 12918784
  s_waitcnt lgkmcnt(0)
  s_barrier
  s_cmp_lg_u32 s87, 0
  s_cbranch_scc1 K1_SE
  ds_read2st64_b32 v[32:33], v4 offset0:0 offset1:1
  ds_read2st64_b32 v[34:35], v4 offset0:2 offset1:3
  ds_read2st64_b32 v[36:37], v4 offset0:4 offset1:5
  ds_read2st64_b32 v[38:39], v4 offset0:6 offset1:7
  ds_read2st64_b32 v[40:41], v4 offset0:8 offset1:9
  ds_read2st64_b32 v[42:43], v4 offset0:10 offset1:11
  ds_read2st64_b32 v[44:45], v4 offset0:12 offset1:13
  ds_read2st64_b32 v[46:47], v4 offset0:14 offset1:15
  s_waitcnt lgkmcnt(0)
  v_pk_add_f32 v[32:33], v[32:33], v[40:41]
  v_pk_add_f32 v[34:35], v[34:35], v[42:43]
  v_pk_add_f32 v[36:37], v[36:37], v[44:45]
  v_pk_add_f32 v[38:39], v[38:39], v[46:47]
  v_pk_add_f32 v[32:33], v[32:33], v[36:37]
  v_pk_add_f32 v[34:35], v[34:35], v[38:39]
  v_pk_add_f32 v[32:33], v[32:33], v[34:35]
  v_mul_f32 v14, 0x3b124925, v32
  v_mul_f32 v15, 0x3b124925, v33
  v_fma_f32 v15, -v14, v14, v15
  v_max_f32 v15, 0, v15
  v_cvt_pk_bf16_f32 v15, v15, v15
  v_lshlrev_b32 v15, 16, v15
  v_add_f32 v15, 0x3727c5ac, v15
  v_cvt_pk_bf16_f32 v15, v15, v15
  v_lshlrev_b32 v15, 16, v15
  v_sqrt_f32 v15, v15
  s_nop 0
  v_cvt_pk_bf16_f32 v15, -v14, v15
  buffer_store_dword v15, v4, s[28:31], s9 offen sc1
  s_nop 0
K1_SE:
  s_and_b32 s6, s5, 30
  s_add_u32 s6, s6, s5
  s_mul_i32 s6, s6, 114688
  s_add_u32 s6, s6, 5734400
  s_lshl_b32 s9, s5, 7
  s_add_u32 s9, s9, 12931072
  s_barrier
  v_mov_b32 v8, -1
  v_mov_b32 v9, -1
  v_mov_b32 v10, -1
  v_mov_b32 v11, -1
  v_lshlrev_b32 v4, 4, v0
  s_movk_i32 s7, 13
  s_nop 0
K1_SFB:
  buffer_store_dwordx4 v[8:11], v4, s[28:31], s6 offen sc1
  s_add_u32 s6, s6, 8192
  s_sub_u32 s7, s7, 1
  s_cbranch_scc0 K1_SFB
  s_waitcnt vmcnt(0)
  s_barrier
  s_cmp_lg_u32 s87, 0
  s_cbranch_scc1 K1_SZ
  s_mov_b64 exec, 1
  buffer_store_dword v8, off, s[28:31], s9 sc1
  s_mov_b64 exec, -1
K1_SZ:
  s_mov_b32 s100, 20
  s_cmp_eq_u32 s3, 18
  s_cbranch_scc1 K1_MOD
K1_END:
  s_endpgm
K1_EXIT:
  s_endpgm
.p2align 4
.type KTAB,@object
KTAB:
  .short 0, 0, 0, 0, 0, 0, 0, 0, 0, 144, 288, 432, 576, 720, 864, 1008
  .short 4, 148, 292, 436, 580, 724, 868, 1012, 8, 152, 296, 440, 584, 728, 872, 1016
  .short 12, 156, 300, 444, 588, 732, 876, 1020, 16, 160, 304, 448, 592, 736, 880, 1024
  .short 20, 164, 308, 452, 596, 740, 884, 1028, 24, 168, 312, 456, 600, 744, 888, 1032
  .short 28, 172, 316, 460, 604, 748, 892, 1036, 32, 176, 320, 464, 608, 752, 896, 1040
  .short 36, 180, 324, 468, 612, 756, 900, 1044, 40, 184, 328, 472, 616, 760, 904, 1048
  .short 44, 188, 332, 476, 620, 764, 908, 1052, 48, 192, 336, 480, 624, 768, 912, 1056
  .short 52, 196, 340, 484, 628, 772, 916, 1060, 56, 200, 344, 488, 632, 776, 920, 1064
  .short 60, 204, 348, 492, 636, 780, 924, 1068, 64, 208, 352, 496, 640, 784, 928, 1072
  .short 68, 212, 356, 500, 644, 788, 932, 1076, 72, 216, 360, 504, 648, 792, 936, 1080
  .short 76, 220, 364, 508, 652, 796, 940, 1084, 80, 224, 368, 512, 656, 800, 944, 1088
  .short 84, 228, 372, 516, 660, 804, 948, 1092, 88, 232, 376, 520, 664, 808, 952, 1096
  .short 92, 236, 380, 524, 668, 812, 956, 1100, 96, 240, 384, 528, 672, 816, 960, 1104
  .short 100, 244, 388, 532, 676, 820, 964, 1108, 104, 248, 392, 536, 680, 824, 968, 1112
  .short 108, 252, 396, 540, 684, 828, 972, 1116, 112, 256, 400, 544, 688, 832, 976, 1120
  .short 116, 260, 404, 548, 692, 836, 980, 1124, 120, 264, 408, 552, 696, 840, 984, 1128
  .short 124, 268, 412, 556, 700, 844, 988, 1132, 1152, 1152, 1296, 1440, 1440, 1440, 1584, 1156
  .short 1156, 1156, 1300, 1444, 1444, 1444, 1588, 1160, 1160, 1160, 1304, 1448, 1448, 1448, 1592, 1164
  .short 1164, 1164, 1308, 1452, 1452, 1452, 1596, 1168, 1168, 1168, 1312, 1456, 1456, 1456, 1600, 1172
  .short 1172, 1172, 1316, 1460, 1460, 1460, 1604, 1176, 1176, 1176, 1320, 1464, 1464, 1464, 1608, 1180
  .short 1180, 1180, 1324, 1468, 1468, 1468, 1612, 1184, 1184, 1184, 1328, 1472, 1472, 1472, 1616, 1188
  .short 1188, 1188, 1332, 1476, 1476, 1476, 1620, 1192, 1192, 1192, 1336, 1480, 1480, 1480, 1624, 1196
  .short 1196, 1196, 1340, 1484, 1484, 1484, 1628, 1200, 1200, 1200, 1344, 1488, 1488, 1488, 1632, 1204
  .short 1204, 1204, 1348, 1492, 1492, 1492, 1636, 1208, 1208, 1208, 1352, 1496, 1496, 1496, 1640, 1212
  .short 1212, 1212, 1356, 1500, 1500, 1500, 1644, 1216, 1216, 1216, 1360, 1504, 1504, 1504, 1648, 1220
  .short 1220, 1220, 1364, 1508, 1508, 1508, 1652, 1224, 1224, 1224, 1368, 1512, 1512, 1512, 1656, 1228
  .short 1228, 1228, 1372, 1516, 1516, 1516, 1660, 1232, 1232, 1232, 1376, 1520, 1520, 1520, 1664, 1236
  .short 1236, 1236, 1380, 1524, 1524, 1524, 1668, 1240, 1240, 1240, 1384, 1528, 1528, 1528, 1672, 1244
  .short 1244, 1244, 1388, 1532, 1532, 1532, 1676, 1248, 1248, 1248, 1392, 1536, 1536, 1536, 1680, 1252
  .short 1252, 1252, 1396, 1540, 1540, 1540, 1684, 1256, 1256, 1256, 1400, 1544, 1544, 1544, 1688, 1260
  .short 1260, 1260, 1404, 1548, 1548, 1548, 1692, 1264, 1264, 1264, 1408, 1552, 1552, 1552, 1696, 1268
  .short 1268, 1268, 1412, 1556, 1556, 1556, 1700, 1272, 1272, 1272, 1416, 1560, 1560, 1560, 1704, 1276
  .short 1276, 1276, 1420, 1564, 1564, 1564, 1708, 1728, 1728, 1728, 1728, 1872, 1872, 1872, 1732, 1732
  .short 1732, 1732, 1732, 1876, 1876, 1876, 1736, 1736, 1736, 1736, 1736, 1880, 1880, 1880, 1740, 1740
  .short 1740, 1740, 1740, 1884, 1884, 1884, 1744, 1744, 1744, 1744, 1744, 1888, 1888, 1888, 1748, 1748
  .short 1748, 1748, 1748, 1892, 1892, 1892, 1752, 1752, 1752, 1752, 1752, 1896, 1896, 1896, 1756, 1756
  .short 1756, 1756, 1756, 1900, 1900, 1900, 1760, 1760, 1760, 1760, 1760, 1904, 1904, 1904, 1764, 1764
  .short 1764, 1764, 1764, 1908, 1908, 1908, 1768, 1768, 1768, 1768, 1768, 1912, 1912, 1912, 1772, 1772
  .short 1772, 1772, 1772, 1916, 1916, 1916, 1776, 1776, 1776, 1776, 1776, 1920, 1920, 1920, 1780, 1780
  .short 1780, 1780, 1780, 1924, 1924, 1924, 1784, 1784, 1784, 1784, 1784, 1928, 1928, 1928, 1788, 1788
  .short 1788, 1788, 1788, 1932, 1932, 1932, 1792, 1792, 1792, 1792, 1792, 1936, 1936, 1936, 1796, 1796
  .short 1796, 1796, 1796, 1940, 1940, 1940, 1800, 1800, 1800, 1800, 1800, 1944, 1944, 1944, 1804, 1804
  .short 1804, 1804, 1804, 1948, 1948, 1948, 1808, 1808, 1808, 1808, 1808, 1952, 1952, 1952, 1812, 1812
  .short 1812, 1812, 1812, 1956, 1956, 1956, 1816, 1816, 1816, 1816, 1816, 1960, 1960, 1960, 1820, 1820
  .short 1820, 1820, 1820, 1964, 1964, 1964, 1824, 1824, 1824, 1824, 1824, 1968, 1968, 1968, 1828, 1828
  .short 1828, 1828, 1828, 1972, 1972, 1972, 1832, 1832, 1832, 1832, 1832, 1976, 1976, 1976, 1836, 1836
  .short 1836, 1836, 1836, 1980, 1980, 1980, 1840, 1840, 1840, 1840, 1840, 1984, 1984, 1984, 1844, 1844
  .short 1844, 1844, 1844, 1988, 1988, 1988, 1848, 1848, 1848, 1848, 1848, 1992, 1992, 1992, 1852, 1852
  .short 1852, 1852, 1852, 1996, 1996, 1996, 2016, 2016, 2016, 2016, 2016, 2160, 2160, 2160, 2020, 2020
  .short 2020, 2020, 2020, 2164, 2164, 2164, 2024, 2024, 2024, 2024, 2024, 2168, 2168, 2168, 2028, 2028
  .short 2028, 2028, 2028, 2172, 2172, 2172, 2032, 2032, 2032, 2032, 2032, 2176, 2176, 2176, 2036, 2036
  .short 2036, 2036, 2036, 2180, 2180, 2180, 2040, 2040, 2040, 2040, 2040, 2184, 2184, 2184, 2044, 2044
  .short 2044, 2044, 2044, 2188, 2188, 2188, 2048, 2048, 2048, 2048, 2048, 2192, 2192, 2192, 2052, 2052
  .short 2052, 2052, 2052, 2196, 2196, 2196, 2056, 2056, 2056, 2056, 2056, 2200, 2200, 2200, 2060, 2060
  .short 2060, 2060, 2060, 2204, 2204, 2204, 2064, 2064, 2064, 2064, 2064, 2208, 2208, 2208, 2068, 2068
  .short 2068, 2068, 2068, 2212, 2212, 2212, 2072, 2072, 2072, 2072, 2072, 2216, 2216, 2216, 2076, 2076
  .short 2076, 2076, 2076, 2220, 2220, 2220, 2080, 2080, 2080, 2080, 2080, 2224, 2224, 2224, 2084, 2084
  .short 2084, 2084, 2084, 2228, 2228, 2228, 2088, 2088, 2088, 2088, 2088, 2232, 2232, 2232, 2092, 2092
  .short 2092, 2092, 2092, 2236, 2236, 2236, 2096, 2096, 2096, 2096, 2096, 2240, 2240, 2240, 2100, 2100
  .short 2100, 2100, 2100, 2244, 2244, 2244, 2104, 2104, 2104, 2104, 2104, 2248, 2248, 2248, 2108, 2108
  .short 2108, 2108, 2108, 2252, 2252, 2252, 2112, 2112, 2112, 2112, 2112, 2256, 2256, 2256, 2116, 2116
  .short 2116, 2116, 2116, 2260, 2260, 2260, 2120, 2120, 2120, 2120, 2120, 2264, 2264, 2264, 2124, 2124
  .short 2124, 2124, 2124, 2268, 2268, 2268, 2128, 2128, 2128, 2128, 2128, 2272, 2272, 2272, 2132, 2132
  .short 2132, 2132, 2132, 2276, 2276, 2276, 2136, 2136, 2136, 2136, 2136, 2280, 2280, 2280, 2140, 2140
  .short 2140, 2140, 2140, 2284, 2284, 2284, 2304, 2304, 2304, 2304, 2304, 2304, 2304, 2308, 2308, 2308
  .short 2308, 2308, 2308, 2308, 2312, 2312, 2312, 2312, 2312, 2312, 2312, 2312, 2312, 2316, 2316, 2316
  .short 2316, 2316, 2316, 2316, 2320, 2320, 2320, 2320, 2320, 2320, 2320, 2320, 2320, 2324, 2324, 2324
  .short 2324, 2324, 2324, 2324, 2328, 2328, 2328, 2328, 2328, 2328, 2328, 2328, 2328, 2332, 2332, 2332
  .short 2332, 2332, 2332, 2332, 2336, 2336, 2336, 2336, 2336, 2336, 2336, 2336, 2336, 2340, 2340, 2340
  .short 2340, 2340, 2340, 2340, 2344, 2344, 2344, 2344, 2344, 2344, 2344, 2344, 2344, 2348, 2348, 2348
  .short 2348, 2348, 2348, 2348, 2352, 2352, 2352, 2352, 2352, 2352, 2352, 2352, 2352, 2356, 2356, 2356
  .short 2356, 2356, 2356, 2356, 2360, 2360, 2360, 2360, 2360, 2360, 2360, 2360, 2360, 2364, 2364, 2364
  .short 2364, 2364, 2364, 2364, 2368, 2368, 2368, 2368, 2368, 2368, 2368, 2368, 2368, 2372, 2372, 2372
  .short 2372, 2372, 2372, 2372, 2376, 2376, 2376, 2376, 2376, 2376, 2376, 2376, 2376, 2380, 2380, 2380
  .short 2380, 2380, 2380, 2380, 2384, 2384, 2384, 2384, 2384, 2384, 2384, 2384, 2384, 2388, 2388, 2388
  .short 2388, 2388, 2388, 2388, 2392, 2392, 2392, 2392, 2392, 2392, 2392, 2392, 2392, 2396, 2396, 2396
  .short 2396, 2396, 2396, 2396, 2400, 2400, 2400, 2400, 2400, 2400, 2400, 2400, 2400, 2404, 2404, 2404
  .short 2404, 2404, 2404, 2404, 2408, 2408, 2408, 2408, 2408, 2408, 2408, 2408, 2408, 2412, 2412, 2412
  .short 2412, 2412, 2412, 2412, 2416, 2416, 2416, 2416, 2416, 2416, 2416, 2416, 2416, 2420, 2420, 2420
  .short 2420, 2420, 2420, 2420, 2424, 2424, 2424, 2424, 2424, 2424, 2424, 2424, 2424, 2428, 2428, 2428
  .short 2428, 2428, 2428, 2428, 2448, 2448, 2448, 2448, 2448, 2448, 2448, 2448, 2448, 2452, 2452, 2452
  .short 2452, 2452, 2452, 2452, 2456, 2456, 2456, 2456, 2456, 2456, 2456, 2456, 2456, 2460, 2460, 2460
  .short 2460, 2460, 2460, 2460, 2464, 2464, 2464, 2464, 2464, 2464, 2464, 2464, 2464, 2468, 2468, 2468
  .short 2468, 2468, 2468, 2468, 2472, 2472, 2472, 2472, 2472, 2472, 2472, 2472, 2472, 2476, 2476, 2476
  .short 2476, 2476, 2476, 2476, 2480, 2480, 2480, 2480, 2480, 2480, 2480, 2480, 2480, 2484, 2484, 2484
  .short 2484, 2484, 2484, 2484, 2488, 2488, 2488, 2488, 2488, 2488, 2488, 2488, 2488, 2492, 2492, 2492
  .short 2492, 2492, 2492, 2492, 2496, 2496, 2496, 2496, 2496, 2496, 2496, 2496, 2496, 2500, 2500, 2500
  .short 2500, 2500, 2500, 2500, 2504, 2504, 2504, 2504, 2504, 2504, 2504, 2504, 2504, 2508, 2508, 2508
  .short 2508, 2508, 2508, 2508, 2512, 2512, 2512, 2512, 2512, 2512, 2512, 2512, 2512, 2516, 2516, 2516
  .short 2516, 2516, 2516, 2516, 2520, 2520, 2520, 2520, 2520, 2520, 2520, 2520, 2520, 2524, 2524, 2524
  .short 2524, 2524, 2524, 2524, 2528, 2528, 2528, 2528, 2528, 2528, 2528, 2528, 2528, 2532, 2532, 2532
  .short 2532, 2532, 2532, 2532, 2536, 2536, 2536, 2536, 2536, 2536, 2536, 2536, 2536, 2540, 2540, 2540
  .short 2540, 2540, 2540, 2540, 2544, 2544, 2544, 2544, 2544, 2544, 2544, 2544, 2544, 2548, 2548, 2548
  .short 2548, 2548, 2548, 2548, 2552, 2552, 2552, 2552, 2552, 2552, 2552, 2552, 2552, 2556, 2556, 2556
  .short 2556, 2556, 2556, 2556, 2560, 2560, 2560, 2560, 2560, 2560, 2560, 2560, 2560, 2564, 2564, 2564
  .short 2564, 2564, 2564, 2564, 2568, 2568, 2568, 2568, 2568, 2568, 2568, 2568, 2568, 2572, 2572, 2572
  .short 2572, 2572, 2572, 2572, 2592, 2592, 2592, 2592, 2592, 2592, 2592, 2592, 2592, 2596, 2596, 2596
  .short 2596, 2596, 2596, 2596, 2600, 2600, 2600, 2600, 2600, 2600, 2600, 2600, 2600, 2604, 2604, 2604
  .short 2604, 2604, 2604, 2604, 2608, 2608, 2608, 2608, 2608, 2608, 2608, 2608, 2608, 2612, 2612, 2612
  .short 2612, 2612, 2612, 2612, 2616, 2616, 2616, 2616, 2616, 2616, 2616, 2616, 2616, 2620, 2620, 2620
  .short 2620, 2620, 2620, 2620, 2624, 2624, 2624, 2624, 2624, 2624, 2624, 2624, 2624, 2628, 2628, 2628
  .short 2628, 2628, 2628, 2628, 2632, 2632, 2632, 2632, 2632, 2632, 2632, 2632, 2632, 2636, 2636, 2636
  .short 2636, 2636, 2636, 2636, 2640, 2640, 2640, 2640, 2640, 2640, 2640, 2640, 2640, 2644, 2644, 2644
  .short 2644, 2644, 2644, 2644, 2648, 2648, 2648, 2648, 2648, 2648, 2648, 2648, 2648, 2652, 2652, 2652
  .short 2652, 2652, 2652, 2652, 2656, 2656, 2656, 2656, 2656, 2656, 2656, 2656, 2656, 2660, 2660, 2660
  .short 2660, 2660, 2660, 2660, 2664, 2664, 2664, 2664, 2664, 2664, 2664, 2664, 2664, 2668, 2668, 2668
  .short 2668, 2668, 2668, 2668, 2672, 2672, 2672, 2672, 2672, 2672, 2672, 2672, 2672, 2676, 2676, 2676
  .short 2676, 2676, 2676, 2676, 2680, 2680, 2680, 2680, 2680, 2680, 2680, 2680, 2680, 2684, 2684, 2684
  .short 2684, 2684, 2684, 2684, 2688, 2688, 2688, 2688, 2688, 2688, 2688, 2688, 2688, 2692, 2692, 2692
  .short 2692, 2692, 2692, 2692, 2696, 2696, 2696, 2696, 2696, 2696, 2696, 2696, 2696, 2700, 2700, 2700
  .short 2700, 2700, 2700, 2700, 2704, 2704, 2704, 2704, 2704, 2704, 2704, 2704, 2704, 2708, 2708, 2708
  .short 2708, 2708, 2708, 2708, 2712, 2712, 2712, 2712, 2712, 2712, 2712, 2712, 2712, 2716, 2716, 2716
  .short 2716, 2716, 2716, 2716, 2736, 2736, 2736, 2736, 2736, 2736, 2736, 2736, 2736, 2740, 2740, 2740
  .short 2740, 2740, 2740, 2740, 2744, 2744, 2744, 2744, 2744, 2744, 2744, 2744, 2744, 2748, 2748, 2748
  .short 2748, 2748, 2748, 2748, 2752, 2752, 2752, 2752, 2752, 2752, 2752, 2752, 2752, 2756, 2756, 2756
  .short 2756, 2756, 2756, 2756, 2760, 2760, 2760, 2760, 2760, 2760, 2760, 2760, 2760, 2764, 2764, 2764
  .short 2764, 2764, 2764, 2764, 2768, 2768, 2768, 2768, 2768, 2768, 2768, 2768, 2768, 2772, 2772, 2772
  .short 2772, 2772, 2772, 2772, 2776, 2776, 2776, 2776, 2776, 2776, 2776, 2776, 2776, 2780, 2780, 2780
  .short 2780, 2780, 2780, 2780, 2784, 2784, 2784, 2784, 2784, 2784, 2784, 2784, 2784, 2788, 2788, 2788
  .short 2788, 2788, 2788, 2788, 2792, 2792, 2792, 2792, 2792, 2792, 2792, 2792, 2792, 2796, 2796, 2796
  .short 2796, 2796, 2796, 2796, 2800, 2800, 2800, 2800, 2800, 2800, 2800, 2800, 2800, 2804, 2804, 2804
  .short 2804, 2804, 2804, 2804, 2808, 2808, 2808, 2808, 2808, 2808, 2808, 2808, 2808, 2812, 2812, 2812
  .short 2812, 2812, 2812, 2812, 2816, 2816, 2816, 2816, 2816, 2816, 2816, 2816, 2816, 2820, 2820, 2820
  .short 2820, 2820, 2820, 2820, 2824, 2824, 2824, 2824, 2824, 2824, 2824, 2824, 2824, 2828, 2828, 2828
  .short 2828, 2828, 2828, 2828, 2832, 2832, 2832, 2832, 2832, 2832, 2832, 2832, 2832, 2836, 2836, 2836
  .short 2836, 2836, 2836, 2836, 2840, 2840, 2840, 2840, 2840, 2840, 2840, 2840, 2840, 2844, 2844, 2844
  .short 2844, 2844, 2844, 2844, 2848, 2848, 2848, 2848, 2848, 2848, 2848, 2848, 2848, 2852, 2852, 2852
  .short 2852, 2852, 2852, 2852, 2856, 2856, 2856, 2856, 2856, 2856, 2856, 2856, 2856, 2860, 2860, 2860
  .short 2860, 2860, 2860, 2860, 2880, 2880, 2880, 2880
.size KTAB, 4112
K_END:

.section .rodata,"a"
.p2align 6
.amdhsa_kernel kf_kernel
  .amdhsa_next_free_vgpr 256
  .amdhsa_next_free_sgpr 102
  .amdhsa_accum_offset 256
  .amdhsa_group_segment_fixed_size 0
  .amdhsa_kernarg_size 144
  .amdhsa_user_sgpr_count 2
  .amdhsa_user_sgpr_kernarg_segment_ptr 1
  .amdhsa_system_sgpr_workgroup_id_x 1
.end_amdhsa_kernel
```
